```python
import torch

def _softmax(x, axis=-1):
    return torch.softmax(x, dim=axis)
def _gelu(x):
    return torch.nn.functional.gelu(x, approximate="tanh")
def _silu(x):
    return torch.nn.functional.silu(x)
def _sigmoid(x):
    return torch.sigmoid(x)
def _layernorm(x, axis=-1, eps=1e-5):
    m = x.mean(dim=axis, keepdim=True)
    v = x.var(dim=axis, keepdim=True, unbiased=False)
    return (x - m) / torch.sqrt(v + eps)
def _scatter_add(tgt, idx, src, axis=0):
    return tgt.clone().index_add_(axis, idx, src)
def _segment_sum(src, seg, n):
    out = torch.zeros((n,) + src.shape[1:], dtype=src.dtype)
    return out.index_add_(0, seg, src)
def _pad(x, pw):
    flat = tuple(v for pair in reversed(pw) for v in pair)
    return torch.nn.functional.pad(x, flat)

kernel_name = 'sequential_preLN__mha_block__swiglu_ffn__prompt'

def setup_inputs():

    _w = (lambda a: (lambda t: t.to(torch.bfloat16) if t.is_floating_point() else t)(torch.as_tensor(a)))
    def _A_setup():
        B, S, D, H = 1, 2048, 640, 32
        return {
            "x": _w((lambda *s: torch.randn(*s, dtype=torch.bfloat16) * 0.05)(B, S, D)),
            "wqkv": _w((lambda *s: torch.randn(*s, dtype=torch.bfloat16) * 0.05)(D, 3 * D)),
            "wo": _w((lambda *s: torch.randn(*s, dtype=torch.bfloat16) * 0.05)(D, D)),
        }
    _A_in = _A_setup()

    def _B_setup():
        B, S, D, F = 1, 2048, 640, 1728
        return {
            "x": _w((lambda *s: torch.randn(*s, dtype=torch.bfloat16) * 0.05)(B, S, D)),
            "w_gate": _w((lambda *s: torch.randn(*s, dtype=torch.bfloat16) * 0.05)(D, F)),
            "w_up": _w((lambda *s: torch.randn(*s, dtype=torch.bfloat16) * 0.05)(D, F)),
            "w_down": _w((lambda *s: torch.randn(*s, dtype=torch.bfloat16) * 0.05)(F, D)),
        }
    _B_in = _B_setup()

    return {
        "A_x": _A_in["x"],
        "A_wqkv": _A_in["wqkv"],
        "A_wo": _A_in["wo"],
        "B_x": _B_in["x"],
        "B_w_gate": _B_in["w_gate"],
        "B_w_up": _B_in["w_up"],
        "B_w_down": _B_in["w_down"],
    }

def reference(A_x, A_wqkv, A_wo, B_x, B_w_gate, B_w_up, B_w_down):
    def _A_ref(x, wqkv, wo):
        B, S, D = x.shape
        H = 32
        Dh = D // H
        qkv = (lambda x, *d: x.permute(*d))((x @ wqkv).reshape(B, S, 3, H, Dh), 2, 0, 3, 1, 4)
        q, k, v = qkv[0], qkv[1], qkv[2]
        scores = torch.einsum("bhqd,bhkd->bhqk", q, k) * (Dh ** -0.5)
        p = _softmax(scores, axis=-1)
        o = torch.einsum("bhqk,bhkd->bhqd", p, v)
        return (lambda x, *d: x.permute(*d))(o, 0, 2, 1, 3).reshape(B, S, D) @ wo

    def _B_ref(x, w_gate, w_up, w_down):
        g = _silu(x @ w_gate)
        u = x @ w_up
        return (g * u) @ w_down

    x = A_x
    h = x + _A_ref(_layernorm(x, axis=-1), A_wqkv, A_wo)
    h2 = h + _B_ref(_layernorm(h, axis=-1), B_w_gate, B_w_up, B_w_down)
    return h2
```

```asm
; @launch kernel=qkv_kernel grid=(256,1,1) block=(768,1,1) lds=133120
; @launch kernel=attn_kernel grid=(256,1,1) block=(768,1,1) lds=103424
; @launch kernel=wo_kernel grid=(256,1,1) block=(512,1,1) lds=147456
; @launch kernel=gu_kernel grid=(256,1,1) block=(512,1,1) lds=157696
; @launch kernel=down_kernel grid=(256,1,1) block=(512,1,1) lds=147456
.amdgcn_target "amdgcn-amd-amdhsa--gfx950"
.text
.globl qkv_kernel
.p2align 8
.type qkv_kernel,@function
qkv_kernel:
    s_cmp_ge_u32 s2, 256
    s_cbranch_scc1 qkv_kernel_end
    s_load_dwordx16 s[64:79], s[0:1], 0
    s_load_dwordx4 s[80:83], s[0:1], 64
    v_lshrrev_b32 v1, 6, v0
    v_and_b32 v2, 63, v0
    v_readfirstlane_b32 s18, v1
    s_cmp_ge_u32 s2, 240
    s_cbranch_scc1 qkv_kernel_colsum
    s_and_b32 s30, s2, 7
    s_lshr_b32 s31, s2, 3
    s_and_b32 s32, s30, 1
    s_mul_i32 s32, s32, 30
    s_add_u32 s32, s32, s31
    s_lshr_b32 s17, s32, 2
    s_and_b32 s33, s32, 3
    s_lshr_b32 s30, s30, 1
    s_lshl_b32 s30, s30, 2
    s_add_u32 s16, s30, s33
    s_cmp_ge_u32 s18, 8
    s_cbranch_scc1 qkv_kernel_stats
    s_cmp_ge_u32 s18, 4
    s_cbranch_scc0 qkv_kernel_main_loader
    s_sub_u32 s18, s18, 4
    s_mul_i32 s21, s16, 163840
    s_mul_i32 s30, s18, 40960
    s_add_u32 s21, s21, s30
    s_mul_i32 s22, s18, 61440
    s_lshl_b32 s30, s17, 8
    s_add_u32 s22, s22, s30
    s_lshl_b32 s23, s18, 12
    s_add_u32 s24, s23, 16384
    v_lshrrev_b32 v3, 3, v2
    v_and_b32 v4, 7, v2
    v_lshrrev_b32 v5, 1, v3
    v_xor_b32 v6, v4, v5
    v_mul_u32_u24 v3, 1280, v3
    v_lshl_add_u32 v7, v6, 4, v3
    v_xor_b32 v6, 4, v6
    v_lshl_add_u32 v8, v6, 4, v3
    v_lshrrev_b32 v3, 4, v2
    v_and_b32 v4, 15, v2
    v_lshlrev_b32 v5, 2, v3
    v_xor_b32 v4, v4, v5
    v_mul_u32_u24 v3, 3840, v3
    v_lshl_add_u32 v9, v4, 4, v3
    s_waitcnt lgkmcnt(0)
    s_mov_b32 s4, s64
    s_mov_b32 s5, s65
    s_mov_b32 s6, 2621440
    s_mov_b32 s7, 0x00020000
    s_mov_b32 s8, s66
    s_mov_b32 s9, s67
    s_mov_b32 s10, 2457600
    s_mov_b32 s11, 0x00020000
    s_and_b32 s30, s16, 3
    s_mul_i32 s30, s30, 0
    s_mul_i32 s31, s17, 0
    s_add_u32 s44, s30, s31
    s_mul_i32 s30, s44, 6554
    s_lshr_b32 s30, s30, 16
    s_mul_i32 s30, s30, 10
    s_sub_u32 s44, s44, s30
    s_mov_b32 s46, 0
    s_lshl_b32 s47, s44, 7
    s_mul_i32 s48, s44, 245760
    s_add_u32 s30, s24, s46
    s_add_u32 m0, s30, 0
    s_add_u32 s31, s22, s48
    s_add_u32 s31, s31, 0
    buffer_load_dwordx4 v9, s[8:11], s31 offen lds
    s_add_u32 s30, s24, s46
    s_add_u32 m0, s30, 1024
    s_add_u32 s31, s22, s48
    s_add_u32 s31, s31, 15360
    buffer_load_dwordx4 v9, s[8:11], s31 offen lds
    s_add_u32 s30, s24, s46
    s_add_u32 m0, s30, 2048
    s_add_u32 s31, s22, s48
    s_add_u32 s31, s31, 30720
    buffer_load_dwordx4 v9, s[8:11], s31 offen lds
    s_add_u32 s30, s24, s46
    s_add_u32 m0, s30, 3072
    s_add_u32 s31, s22, s48
    s_add_u32 s31, s31, 46080
    buffer_load_dwordx4 v9, s[8:11], s31 offen lds
    s_add_u32 s30, s23, s46
    s_add_u32 m0, s30, 0
    s_add_u32 s31, s21, s47
    s_add_u32 s31, s31, 0
    buffer_load_dwordx4 v7, s[4:7], s31 offen lds
    s_add_u32 s30, s23, s46
    s_add_u32 m0, s30, 1024
    s_add_u32 s31, s21, s47
    s_add_u32 s31, s31, 10240
    buffer_load_dwordx4 v8, s[4:7], s31 offen lds
    s_add_u32 s30, s23, s46
    s_add_u32 m0, s30, 2048
    s_add_u32 s31, s21, s47
    s_add_u32 s31, s31, 20480
    buffer_load_dwordx4 v7, s[4:7], s31 offen lds
    s_add_u32 s30, s23, s46
    s_add_u32 m0, s30, 3072
    s_add_u32 s31, s21, s47
    s_add_u32 s31, s31, 30720
    buffer_load_dwordx4 v8, s[4:7], s31 offen lds
    s_add_u32 s44, s44, 1
    s_cmp_ge_u32 s44, 10
    s_cselect_b32 s30, 10, 0
    s_sub_u32 s44, s44, s30
    s_add_u32 s46, s46, 32768
    s_and_b32 s46, s46, 131071
    s_lshl_b32 s47, s44, 7
    s_mul_i32 s48, s44, 245760
    s_add_u32 s30, s24, s46
    s_add_u32 m0, s30, 0
    s_add_u32 s31, s22, s48
    s_add_u32 s31, s31, 0
    buffer_load_dwordx4 v9, s[8:11], s31 offen lds
    s_add_u32 s30, s24, s46
    s_add_u32 m0, s30, 1024
    s_add_u32 s31, s22, s48
    s_add_u32 s31, s31, 15360
    buffer_load_dwordx4 v9, s[8:11], s31 offen lds
    s_add_u32 s30, s24, s46
    s_add_u32 m0, s30, 2048
    s_add_u32 s31, s22, s48
    s_add_u32 s31, s31, 30720
    buffer_load_dwordx4 v9, s[8:11], s31 offen lds
    s_add_u32 s30, s24, s46
    s_add_u32 m0, s30, 3072
    s_add_u32 s31, s22, s48
    s_add_u32 s31, s31, 46080
    buffer_load_dwordx4 v9, s[8:11], s31 offen lds
    s_add_u32 s30, s23, s46
    s_add_u32 m0, s30, 0
    s_add_u32 s31, s21, s47
    s_add_u32 s31, s31, 0
    buffer_load_dwordx4 v7, s[4:7], s31 offen lds
    s_add_u32 s30, s23, s46
    s_add_u32 m0, s30, 1024
    s_add_u32 s31, s21, s47
    s_add_u32 s31, s31, 10240
    buffer_load_dwordx4 v8, s[4:7], s31 offen lds
    s_add_u32 s30, s23, s46
    s_add_u32 m0, s30, 2048
    s_add_u32 s31, s21, s47
    s_add_u32 s31, s31, 20480
    buffer_load_dwordx4 v7, s[4:7], s31 offen lds
    s_add_u32 s30, s23, s46
    s_add_u32 m0, s30, 3072
    s_add_u32 s31, s21, s47
    s_add_u32 s31, s31, 30720
    buffer_load_dwordx4 v8, s[4:7], s31 offen lds
    s_add_u32 s44, s44, 1
    s_cmp_ge_u32 s44, 10
    s_cselect_b32 s30, 10, 0
    s_sub_u32 s44, s44, s30
    s_add_u32 s46, s46, 32768
    s_and_b32 s46, s46, 131071
    s_waitcnt vmcnt(8)
    s_barrier
    s_lshl_b32 s47, s44, 7
    s_mul_i32 s48, s44, 245760
    s_add_u32 s30, s24, s46
    s_add_u32 m0, s30, 0
    s_add_u32 s31, s22, s48
    s_add_u32 s31, s31, 0
    buffer_load_dwordx4 v9, s[8:11], s31 offen lds
    s_add_u32 s30, s24, s46
    s_add_u32 m0, s30, 1024
    s_add_u32 s31, s22, s48
    s_add_u32 s31, s31, 15360
    buffer_load_dwordx4 v9, s[8:11], s31 offen lds
    s_add_u32 s30, s24, s46
    s_add_u32 m0, s30, 2048
    s_add_u32 s31, s22, s48
    s_add_u32 s31, s31, 30720
    buffer_load_dwordx4 v9, s[8:11], s31 offen lds
    s_add_u32 s30, s24, s46
    s_add_u32 m0, s30, 3072
    s_add_u32 s31, s22, s48
    s_add_u32 s31, s31, 46080
    buffer_load_dwordx4 v9, s[8:11], s31 offen lds
    s_add_u32 s30, s23, s46
    s_add_u32 m0, s30, 0
    s_add_u32 s31, s21, s47
    s_add_u32 s31, s31, 0
    buffer_load_dwordx4 v7, s[4:7], s31 offen lds
    s_add_u32 s30, s23, s46
    s_add_u32 m0, s30, 1024
    s_add_u32 s31, s21, s47
    s_add_u32 s31, s31, 10240
    buffer_load_dwordx4 v8, s[4:7], s31 offen lds
    s_add_u32 s30, s23, s46
    s_add_u32 m0, s30, 2048
    s_add_u32 s31, s21, s47
    s_add_u32 s31, s31, 20480
    buffer_load_dwordx4 v7, s[4:7], s31 offen lds
    s_add_u32 s30, s23, s46
    s_add_u32 m0, s30, 3072
    s_add_u32 s31, s21, s47
    s_add_u32 s31, s31, 30720
    buffer_load_dwordx4 v8, s[4:7], s31 offen lds
    s_add_u32 s44, s44, 1
    s_cmp_ge_u32 s44, 10
    s_cselect_b32 s30, 10, 0
    s_sub_u32 s44, s44, s30
    s_add_u32 s46, s46, 32768
    s_and_b32 s46, s46, 131071
    s_lshl_b32 s47, s44, 7
    s_mul_i32 s48, s44, 245760
    s_add_u32 s30, s24, s46
    s_add_u32 m0, s30, 0
    s_add_u32 s31, s22, s48
    s_add_u32 s31, s31, 0
    buffer_load_dwordx4 v9, s[8:11], s31 offen lds
    s_add_u32 s30, s24, s46
    s_add_u32 m0, s30, 1024
    s_add_u32 s31, s22, s48
    s_add_u32 s31, s31, 15360
    buffer_load_dwordx4 v9, s[8:11], s31 offen lds
    s_add_u32 s30, s24, s46
    s_add_u32 m0, s30, 2048
    s_add_u32 s31, s22, s48
    s_add_u32 s31, s31, 30720
    buffer_load_dwordx4 v9, s[8:11], s31 offen lds
    s_add_u32 s30, s24, s46
    s_add_u32 m0, s30, 3072
    s_add_u32 s31, s22, s48
    s_add_u32 s31, s31, 46080
    buffer_load_dwordx4 v9, s[8:11], s31 offen lds
    s_add_u32 s30, s23, s46
    s_add_u32 m0, s30, 0
    s_add_u32 s31, s21, s47
    s_add_u32 s31, s31, 0
    buffer_load_dwordx4 v7, s[4:7], s31 offen lds
    s_add_u32 s30, s23, s46
    s_add_u32 m0, s30, 1024
    s_add_u32 s31, s21, s47
    s_add_u32 s31, s31, 10240
    buffer_load_dwordx4 v8, s[4:7], s31 offen lds
    s_add_u32 s30, s23, s46
    s_add_u32 m0, s30, 2048
    s_add_u32 s31, s21, s47
    s_add_u32 s31, s31, 20480
    buffer_load_dwordx4 v7, s[4:7], s31 offen lds
    s_add_u32 s30, s23, s46
    s_add_u32 m0, s30, 3072
    s_add_u32 s31, s21, s47
    s_add_u32 s31, s31, 30720
    buffer_load_dwordx4 v8, s[4:7], s31 offen lds
    s_add_u32 s44, s44, 1
    s_cmp_ge_u32 s44, 10
    s_cselect_b32 s30, 10, 0
    s_sub_u32 s44, s44, s30
    s_add_u32 s46, s46, 32768
    s_and_b32 s46, s46, 131071
    s_mov_b32 s49, 1
qkv_kernel_lloop:
    s_waitcnt vmcnt(16)
    s_barrier
    s_lshl_b32 s47, s44, 7
    s_mul_i32 s48, s44, 245760
    s_add_u32 s30, s24, s46
    s_add_u32 m0, s30, 0
    s_add_u32 s31, s22, s48
    s_add_u32 s31, s31, 0
    buffer_load_dwordx4 v9, s[8:11], s31 offen lds
    s_add_u32 s30, s24, s46
    s_add_u32 m0, s30, 1024
    s_add_u32 s31, s22, s48
    s_add_u32 s31, s31, 15360
    buffer_load_dwordx4 v9, s[8:11], s31 offen lds
    s_add_u32 s30, s24, s46
    s_add_u32 m0, s30, 2048
    s_add_u32 s31, s22, s48
    s_add_u32 s31, s31, 30720
    buffer_load_dwordx4 v9, s[8:11], s31 offen lds
    s_add_u32 s30, s24, s46
    s_add_u32 m0, s30, 3072
    s_add_u32 s31, s22, s48
    s_add_u32 s31, s31, 46080
    buffer_load_dwordx4 v9, s[8:11], s31 offen lds
    s_add_u32 s30, s23, s46
    s_add_u32 m0, s30, 0
    s_add_u32 s31, s21, s47
    s_add_u32 s31, s31, 0
    buffer_load_dwordx4 v7, s[4:7], s31 offen lds
    s_add_u32 s30, s23, s46
    s_add_u32 m0, s30, 1024
    s_add_u32 s31, s21, s47
    s_add_u32 s31, s31, 10240
    buffer_load_dwordx4 v8, s[4:7], s31 offen lds
    s_add_u32 s30, s23, s46
    s_add_u32 m0, s30, 2048
    s_add_u32 s31, s21, s47
    s_add_u32 s31, s31, 20480
    buffer_load_dwordx4 v7, s[4:7], s31 offen lds
    s_add_u32 s30, s23, s46
    s_add_u32 m0, s30, 3072
    s_add_u32 s31, s21, s47
    s_add_u32 s31, s31, 30720
    buffer_load_dwordx4 v8, s[4:7], s31 offen lds
    s_add_u32 s44, s44, 1
    s_cmp_ge_u32 s44, 10
    s_cselect_b32 s30, 10, 0
    s_sub_u32 s44, s44, s30
    s_add_u32 s46, s46, 32768
    s_and_b32 s46, s46, 131071
    s_add_u32 s49, s49, 1
    s_cmp_le_u32 s49, 6
    s_cbranch_scc1 qkv_kernel_lloop
    s_waitcnt vmcnt(16)
    s_barrier
    s_waitcnt vmcnt(8)
    s_barrier
    s_waitcnt vmcnt(0)
    s_barrier
    s_barrier
    s_branch qkv_kernel_end
qkv_kernel_main_loader:
    s_cmp_lg_u32 s18, 0
    s_cbranch_scc1 qkv_kernel_npf
    s_cmp_ge_u32 s2, 16
    s_cbranch_scc1 qkv_kernel_npf
    s_getpc_b64 s[44:45]
qkv_kernel_pc:
    s_sub_u32 s44, s44, qkv_kernel_pc-qkv_kernel
    s_subb_u32 s45, s45, 0
    s_mov_b32 s46, (wo_kernel-qkv_kernel)>>7
    v_lshlrev_b32 v144, 7, v2
    v_mov_b32 v145, v2
    v_cmp_gt_u32 vcc, s46, v145
    s_and_saveexec_b64 s[48:49], vcc
    s_cbranch_execz qkv_kernel_npf2
    global_load_dword v146, v144, s[44:45]
    s_mov_b64 exec, -1
    v_add_u32 v144, 0x2000, v144
    v_add_u32 v145, 64, v145
    v_cmp_gt_u32 vcc, s46, v145
    s_and_saveexec_b64 s[48:49], vcc
    s_cbranch_execz qkv_kernel_npf2
    global_load_dword v146, v144, s[44:45]
    s_mov_b64 exec, -1
    v_add_u32 v144, 0x2000, v144
    v_add_u32 v145, 64, v145
    v_cmp_gt_u32 vcc, s46, v145
    s_and_saveexec_b64 s[48:49], vcc
    s_cbranch_execz qkv_kernel_npf2
    global_load_dword v146, v144, s[44:45]
    s_mov_b64 exec, -1
    v_add_u32 v144, 0x2000, v144
    v_add_u32 v145, 64, v145
qkv_kernel_npf2:
    s_mov_b64 exec, -1
qkv_kernel_npf:
    s_lshr_b32 s19, s18, 1
    s_and_b32 s20, s18, 1
    v_and_b32 v3, 31, v2
    v_lshrrev_b32 v4, 5, v2
    v_bfe_u32 v5, v3, 1, 3
    v_xor_b32 v5, v5, v4
    v_lshlrev_b32 v5, 4, v5
    v_lshl_add_u32 v5, v3, 7, v5
    s_lshl_b32 s30, s19, 13
    s_lshl_b32 s31, s20, 12
    s_add_u32 s30, s30, s31
    v_add_u32 v5, s30, v5
    v_xor_b32 v7, 0, v5
    v_xor_b32 v8, 0x1000, v7
    v_xor_b32 v9, 32, v5
    v_xor_b32 v10, 0x1000, v9
    v_xor_b32 v11, 64, v5
    v_xor_b32 v12, 0x1000, v11
    v_xor_b32 v13, 96, v5
    v_xor_b32 v14, 0x1000, v13
    v_lshrrev_b32 v3, 5, v2
    v_bfe_u32 v4, v2, 2, 2
    v_lshl_add_u32 v3, v3, 3, v4
    v_lshlrev_b32 v3, 8, v3
    v_bfe_u32 v5, v2, 4, 1
    v_lshlrev_b32 v5, 1, v5
    v_bfe_u32 v6, v2, 1, 1
    v_add_u32 v5, v5, v6
    s_lshl_b32 s30, s20, 3
    s_lshl_b32 s31, s19, 2
    s_add_u32 s30, s30, s31
    v_add_u32 v5, s30, v5
    v_lshlrev_b32 v4, 2, v4
    v_xor_b32 v5, v5, v4
    v_lshl_add_u32 v3, v5, 4, v3
    v_and_b32 v6, 1, v2
    v_lshl_add_u32 v15, v6, 3, v3
    v_add_u32 v15, 16384, v15
    v_xor_b32 v16, 64, v15
    v_mov_b32 v60, 0
    v_mov_b32 v61, 0
    v_mov_b32 v62, 0
    v_mov_b32 v63, 0
    v_mov_b32 v64, 0
    v_mov_b32 v65, 0
    v_mov_b32 v66, 0
    v_mov_b32 v67, 0
    v_mov_b32 v68, 0
    v_mov_b32 v69, 0
    v_mov_b32 v70, 0
    v_mov_b32 v71, 0
    v_mov_b32 v72, 0
    v_mov_b32 v73, 0
    v_mov_b32 v74, 0
    v_mov_b32 v75, 0
    v_mov_b32 v76, 0
    v_mov_b32 v77, 0
    v_mov_b32 v78, 0
    v_mov_b32 v79, 0
    v_mov_b32 v80, 0
    v_mov_b32 v81, 0
    v_mov_b32 v82, 0
    v_mov_b32 v83, 0
    v_mov_b32 v84, 0
    v_mov_b32 v85, 0
    v_mov_b32 v86, 0
    v_mov_b32 v87, 0
    v_mov_b32 v88, 0
    v_mov_b32 v89, 0
    v_mov_b32 v90, 0
    v_mov_b32 v91, 0
    v_mov_b32 v92, 0
    v_mov_b32 v93, 0
    v_mov_b32 v94, 0
    v_mov_b32 v95, 0
    v_mov_b32 v96, 0
    v_mov_b32 v97, 0
    v_mov_b32 v98, 0
    v_mov_b32 v99, 0
    v_mov_b32 v100, 0
    v_mov_b32 v101, 0
    v_mov_b32 v102, 0
    v_mov_b32 v103, 0
    v_mov_b32 v104, 0
    v_mov_b32 v105, 0
    v_mov_b32 v106, 0
    v_mov_b32 v107, 0
    v_mov_b32 v108, 0
    v_mov_b32 v109, 0
    v_mov_b32 v110, 0
    v_mov_b32 v111, 0
    v_mov_b32 v112, 0
    v_mov_b32 v113, 0
    v_mov_b32 v114, 0
    v_mov_b32 v115, 0
    v_mov_b32 v116, 0
    v_mov_b32 v117, 0
    v_mov_b32 v118, 0
    v_mov_b32 v119, 0
    v_mov_b32 v120, 0
    v_mov_b32 v121, 0
    v_mov_b32 v122, 0
    v_mov_b32 v123, 0
    v_mov_b32 v124, 0
    v_mov_b32 v125, 0
    v_mov_b32 v126, 0
    v_mov_b32 v127, 0
    v_mov_b32 v128, 0
    v_mov_b32 v129, 0
    v_mov_b32 v130, 0
    v_mov_b32 v131, 0
    v_mov_b32 v132, 0
    v_mov_b32 v133, 0
    v_mov_b32 v134, 0
    v_mov_b32 v135, 0
    v_mov_b32 v136, 0
    v_mov_b32 v137, 0
    v_mov_b32 v138, 0
    v_mov_b32 v139, 0
    v_mov_b32 v36, 0
    v_mov_b32 v52, 0
    v_mov_b32 v40, 0
    v_mov_b32 v56, 0
    v_mov_b32 v37, 0
    v_mov_b32 v53, 0
    v_mov_b32 v41, 0
    v_mov_b32 v57, 0
    v_mov_b32 v38, 0
    v_mov_b32 v54, 0
    v_mov_b32 v42, 0
    v_mov_b32 v58, 0
    v_mov_b32 v39, 0
    v_mov_b32 v55, 0
    v_mov_b32 v43, 0
    v_mov_b32 v59, 0
    v_mov_b32 v140, 0x3f803f80
    v_mov_b32 v141, 0x3f803f80
    v_mov_b32 v142, 0x3f803f80
    v_mov_b32 v143, 0x3f803f80
    s_waitcnt lgkmcnt(0)
    s_mov_b32 s12, s82
    s_mov_b32 s13, s83
    s_mov_b32 s14, 7864320
    s_mov_b32 s15, 0x00020000
    s_cmp_ge_u32 s17, 10
    s_cbranch_scc1 qkv_kernel_vpath
    s_mov_b32 s49, 0
    s_mov_b32 s45, 0
qkv_kernel_lq:
    s_waitcnt lgkmcnt(0)
    s_barrier
    v_add_u32 v17, s45, v7
    v_add_u32 v18, s45, v8
    v_add_u32 v25, s45, v15
    v_add_u32 v26, s45, v16
    v_mfma_f32_32x32x16_bf16 v[60:75], v[52:55], v[36:39], v[60:75]
    ds_read_b128 v[28:31], v17
    ds_read_b128 v[32:35], v18
    ds_read_b64_tr_b16 v[44:45], v25 offset:0
    v_mfma_f32_32x32x16_bf16 v[76:91], v[52:55], v[40:43], v[76:91]
    ds_read_b64_tr_b16 v[46:47], v25 offset:1024
    ds_read_b64_tr_b16 v[48:49], v26 offset:0
    ds_read_b64_tr_b16 v[50:51], v26 offset:1024
    v_mfma_f32_32x32x16_bf16 v[124:139], v[52:55], v[140:143], v[124:139]
    v_add_u32 v19, s45, v9
    v_add_u32 v20, s45, v10
    v_add_u32 v21, s45, v11
    v_mfma_f32_32x32x16_bf16 v[92:107], v[56:59], v[36:39], v[92:107]
    v_add_u32 v22, s45, v12
    v_add_u32 v23, s45, v13
    v_add_u32 v24, s45, v14
    v_mfma_f32_32x32x16_bf16 v[108:123], v[56:59], v[40:43], v[108:123]
    s_waitcnt lgkmcnt(0)
    v_mfma_f32_32x32x16_bf16 v[60:75], v[44:47], v[28:31], v[60:75]
    ds_read_b128 v[36:39], v19
    ds_read_b128 v[40:43], v20
    v_mfma_f32_32x32x16_bf16 v[76:91], v[44:47], v[32:35], v[76:91]
    ds_read_b64_tr_b16 v[52:53], v25 offset:4096
    ds_read_b64_tr_b16 v[54:55], v25 offset:5120
    v_mfma_f32_32x32x16_bf16 v[124:139], v[44:47], v[140:143], v[124:139]
    ds_read_b64_tr_b16 v[56:57], v26 offset:4096
    ds_read_b64_tr_b16 v[58:59], v26 offset:5120
    v_mfma_f32_32x32x16_bf16 v[92:107], v[48:51], v[28:31], v[92:107]
    v_mfma_f32_32x32x16_bf16 v[108:123], v[48:51], v[32:35], v[108:123]
    s_waitcnt lgkmcnt(0)
    v_mfma_f32_32x32x16_bf16 v[60:75], v[52:55], v[36:39], v[60:75]
    ds_read_b128 v[28:31], v21
    ds_read_b128 v[32:35], v22
    v_mfma_f32_32x32x16_bf16 v[76:91], v[52:55], v[40:43], v[76:91]
    ds_read_b64_tr_b16 v[44:45], v25 offset:8192
    ds_read_b64_tr_b16 v[46:47], v25 offset:9216
    v_mfma_f32_32x32x16_bf16 v[124:139], v[52:55], v[140:143], v[124:139]
    ds_read_b64_tr_b16 v[48:49], v26 offset:8192
    ds_read_b64_tr_b16 v[50:51], v26 offset:9216
    v_mfma_f32_32x32x16_bf16 v[92:107], v[56:59], v[36:39], v[92:107]
    v_mfma_f32_32x32x16_bf16 v[108:123], v[56:59], v[40:43], v[108:123]
    s_waitcnt lgkmcnt(0)
    v_mfma_f32_32x32x16_bf16 v[60:75], v[44:47], v[28:31], v[60:75]
    ds_read_b128 v[36:39], v23
    ds_read_b128 v[40:43], v24
    v_mfma_f32_32x32x16_bf16 v[76:91], v[44:47], v[32:35], v[76:91]
    ds_read_b64_tr_b16 v[52:53], v25 offset:12288
    ds_read_b64_tr_b16 v[54:55], v25 offset:13312
    v_mfma_f32_32x32x16_bf16 v[124:139], v[44:47], v[140:143], v[124:139]
    ds_read_b64_tr_b16 v[56:57], v26 offset:12288
    ds_read_b64_tr_b16 v[58:59], v26 offset:13312
    v_mfma_f32_32x32x16_bf16 v[92:107], v[48:51], v[28:31], v[92:107]
    v_mfma_f32_32x32x16_bf16 v[108:123], v[48:51], v[32:35], v[108:123]
    s_add_u32 s45, s45, 32768
    s_and_b32 s45, s45, 131071
    s_add_u32 s49, s49, 1
    s_cmp_lt_u32 s49, 10
    s_cbranch_scc1 qkv_kernel_lq
    s_waitcnt lgkmcnt(0)
    v_mfma_f32_32x32x16_bf16 v[60:75], v[52:55], v[36:39], v[60:75]
    v_mfma_f32_32x32x16_bf16 v[76:91], v[52:55], v[40:43], v[76:91]
    v_mfma_f32_32x32x16_bf16 v[124:139], v[52:55], v[140:143], v[124:139]
    v_mfma_f32_32x32x16_bf16 v[92:107], v[56:59], v[36:39], v[92:107]
    v_mfma_f32_32x32x16_bf16 v[108:123], v[56:59], v[40:43], v[108:123]
    s_nop 7
    s_nop 7
    v_lshrrev_b32 v3, 5, v2
    v_lshlrev_b32 v3, 4, v3
    s_lshl_b32 s30, s20, 6
    s_lshl_b32 s31, s19, 5
    s_add_u32 s30, s30, s31
    s_lshl_b32 s30, s30, 2
    s_add_u32 s30, s30, 132096
    v_add_u32 v3, s30, v3
    s_mov_b32 s30, 1
    s_mov_b32 s31, 1
    s_mov_b64 exec, s[30:31]
    ds_write_b128 v3, v[124:127] offset:0
    ds_write_b128 v3, v[128:131] offset:32
    ds_write_b128 v3, v[132:135] offset:64
    ds_write_b128 v3, v[136:139] offset:96
    s_mov_b64 exec, -1
    s_waitcnt lgkmcnt(0)
    s_barrier
    v_and_b32 v3, 31, v2
    s_lshl_b32 s30, s19, 6
    s_lshl_b32 s31, s20, 5
    s_add_u32 s30, s30, s31
    v_add_lshl_u32 v4, v3, s30, 2
    v_add_u32 v4, 131072, v4
    v_xor_b32 v5, 128, v4
    ds_read_b32 v8, v4
    ds_read_b32 v12, v4 offset:512
    ds_read_b32 v10, v5
    ds_read_b32 v14, v5 offset:512
    v_lshrrev_b32 v38, 5, v2
    v_lshlrev_b32 v33, 4, v38
    s_lshl_b32 s30, s20, 8
    s_add_u32 s30, s30, 131072
    v_add_u32 v33, s30, v33
    s_cmp_lt_u32 s17, 5
    s_cselect_b32 s34, 1051011932, 1.0
    s_cselect_b32 s35, 0, 2621440
    s_cselect_b32 s30, 0, 5
    s_sub_u32 s30, s17, s30
    s_lshl_b32 s31, s30, 5
    s_lshl_b32 s33, s20, 4
    s_add_u32 s31, s31, s33
    s_lshl_b32 s31, s31, 8
    s_add_u32 s35, s35, s31
    s_lshl_b32 s31, s16, 2
    s_lshl_b32 s33, s19, 1
    s_add_u32 s31, s31, s33
    s_mul_i32 s31, s31, 40960
    s_add_u32 s35, s35, s31
    v_lshlrev_b32 v32, 9, v38
    v_lshl_add_u32 v32, v3, 4, v32
    s_mul_i32 s46, s20, 40960
    s_sub_u32 s47, 40960, s46
    s_add_u32 s46, s46, s35
    s_add_u32 s47, s47, s35
    s_lshl_b32 s48, s19, 11
    s_sub_u32 s49, 2048, s48
    s_lshl_b32 s50, s19, 7
    s_sub_u32 s51, 128, s50
    v_add_u32 v4, s50, v33
    v_add_u32 v5, s51, v33
    ds_read_b128 v[16:19], v4 offset:1024
    s_waitcnt lgkmcnt(1)
    v_mul_f32 v8, s34, v8
    v_mul_f32 v12, s34, v12
    v_mul_f32 v10, s34, v10
    v_mul_f32 v14, s34, v14
    ds_read_b128 v[20:23], v4 offset:1056
    s_waitcnt lgkmcnt(1)
    v_pk_mul_f32 v[34:35], v[16:17], v[12:13] op_sel_hi:[1,0]
    v_pk_mul_f32 v[36:37], v[18:19], v[12:13] op_sel_hi:[1,0]
    v_pk_fma_f32 v[34:35], v[60:61], v[8:9], v[34:35] op_sel_hi:[1,0,1]
    v_pk_fma_f32 v[36:37], v[62:63], v[8:9], v[36:37] op_sel_hi:[1,0,1]
    v_cvt_pk_bf16_f32 v24, v34, v35
    v_cvt_pk_bf16_f32 v25, v36, v37
    v_pk_mul_f32 v[34:35], v[16:17], v[14:15] op_sel_hi:[1,0]
    v_pk_mul_f32 v[36:37], v[18:19], v[14:15] op_sel_hi:[1,0]
    v_pk_fma_f32 v[34:35], v[76:77], v[10:11], v[34:35] op_sel_hi:[1,0,1]
    v_pk_fma_f32 v[36:37], v[78:79], v[10:11], v[36:37] op_sel_hi:[1,0,1]
    v_cvt_pk_bf16_f32 v28, v34, v35
    v_cvt_pk_bf16_f32 v29, v36, v37
    ds_read_b128 v[16:19], v4 offset:1088
    s_waitcnt lgkmcnt(1)
    v_pk_mul_f32 v[34:35], v[20:21], v[12:13] op_sel_hi:[1,0]
    v_pk_mul_f32 v[36:37], v[22:23], v[12:13] op_sel_hi:[1,0]
    v_pk_fma_f32 v[34:35], v[64:65], v[8:9], v[34:35] op_sel_hi:[1,0,1]
    v_pk_fma_f32 v[36:37], v[66:67], v[8:9], v[36:37] op_sel_hi:[1,0,1]
    v_cvt_pk_bf16_f32 v26, v34, v35
    v_cvt_pk_bf16_f32 v27, v36, v37
    s_nop 1
    v_permlane32_swap_b32 v24, v26
    v_permlane32_swap_b32 v25, v27
    s_add_u32 s30, s46, s48
    buffer_store_dwordx4 v[24:27], v32, s[12:15], s30 offen offset:0 sc1
    v_pk_mul_f32 v[34:35], v[20:21], v[14:15] op_sel_hi:[1,0]
    v_pk_mul_f32 v[36:37], v[22:23], v[14:15] op_sel_hi:[1,0]
    v_pk_fma_f32 v[34:35], v[80:81], v[10:11], v[34:35] op_sel_hi:[1,0,1]
    v_pk_fma_f32 v[36:37], v[82:83], v[10:11], v[36:37] op_sel_hi:[1,0,1]
    v_cvt_pk_bf16_f32 v30, v34, v35
    v_cvt_pk_bf16_f32 v31, v36, v37
    s_nop 1
    v_permlane32_swap_b32 v28, v30
    v_permlane32_swap_b32 v29, v31
    s_add_u32 s30, s47, s48
    buffer_store_dwordx4 v[28:31], v32, s[12:15], s30 offen offset:0 sc1
    ds_read_b128 v[20:23], v4 offset:1120
    s_waitcnt lgkmcnt(1)
    v_pk_mul_f32 v[34:35], v[16:17], v[12:13] op_sel_hi:[1,0]
    v_pk_mul_f32 v[36:37], v[18:19], v[12:13] op_sel_hi:[1,0]
    v_pk_fma_f32 v[34:35], v[68:69], v[8:9], v[34:35] op_sel_hi:[1,0,1]
    v_pk_fma_f32 v[36:37], v[70:71], v[8:9], v[36:37] op_sel_hi:[1,0,1]
    v_cvt_pk_bf16_f32 v24, v34, v35
    v_cvt_pk_bf16_f32 v25, v36, v37
    v_pk_mul_f32 v[34:35], v[16:17], v[14:15] op_sel_hi:[1,0]
    v_pk_mul_f32 v[36:37], v[18:19], v[14:15] op_sel_hi:[1,0]
    v_pk_fma_f32 v[34:35], v[84:85], v[10:11], v[34:35] op_sel_hi:[1,0,1]
    v_pk_fma_f32 v[36:37], v[86:87], v[10:11], v[36:37] op_sel_hi:[1,0,1]
    v_cvt_pk_bf16_f32 v28, v34, v35
    v_cvt_pk_bf16_f32 v29, v36, v37
    ds_read_b128 v[16:19], v5 offset:1024
    s_waitcnt lgkmcnt(1)
    v_pk_mul_f32 v[34:35], v[20:21], v[12:13] op_sel_hi:[1,0]
    v_pk_mul_f32 v[36:37], v[22:23], v[12:13] op_sel_hi:[1,0]
    v_pk_fma_f32 v[34:35], v[72:73], v[8:9], v[34:35] op_sel_hi:[1,0,1]
    v_pk_fma_f32 v[36:37], v[74:75], v[8:9], v[36:37] op_sel_hi:[1,0,1]
    v_cvt_pk_bf16_f32 v26, v34, v35
    v_cvt_pk_bf16_f32 v27, v36, v37
    s_nop 1
    v_permlane32_swap_b32 v24, v26
    v_permlane32_swap_b32 v25, v27
    s_add_u32 s30, s46, s48
    buffer_store_dwordx4 v[24:27], v32, s[12:15], s30 offen offset:1024 sc1
    v_pk_mul_f32 v[34:35], v[20:21], v[14:15] op_sel_hi:[1,0]
    v_pk_mul_f32 v[36:37], v[22:23], v[14:15] op_sel_hi:[1,0]
    v_pk_fma_f32 v[34:35], v[88:89], v[10:11], v[34:35] op_sel_hi:[1,0,1]
    v_pk_fma_f32 v[36:37], v[90:91], v[10:11], v[36:37] op_sel_hi:[1,0,1]
    v_cvt_pk_bf16_f32 v30, v34, v35
    v_cvt_pk_bf16_f32 v31, v36, v37
    s_nop 1
    v_permlane32_swap_b32 v28, v30
    v_permlane32_swap_b32 v29, v31
    s_add_u32 s30, s47, s48
    buffer_store_dwordx4 v[28:31], v32, s[12:15], s30 offen offset:1024 sc1
    ds_read_b128 v[20:23], v5 offset:1056
    s_waitcnt lgkmcnt(1)
    v_pk_mul_f32 v[34:35], v[16:17], v[12:13] op_sel_hi:[1,0]
    v_pk_mul_f32 v[36:37], v[18:19], v[12:13] op_sel_hi:[1,0]
    v_pk_fma_f32 v[34:35], v[92:93], v[8:9], v[34:35] op_sel_hi:[1,0,1]
    v_pk_fma_f32 v[36:37], v[94:95], v[8:9], v[36:37] op_sel_hi:[1,0,1]
    v_cvt_pk_bf16_f32 v24, v34, v35
    v_cvt_pk_bf16_f32 v25, v36, v37
    v_pk_mul_f32 v[34:35], v[16:17], v[14:15] op_sel_hi:[1,0]
    v_pk_mul_f32 v[36:37], v[18:19], v[14:15] op_sel_hi:[1,0]
    v_pk_fma_f32 v[34:35], v[108:109], v[10:11], v[34:35] op_sel_hi:[1,0,1]
    v_pk_fma_f32 v[36:37], v[110:111], v[10:11], v[36:37] op_sel_hi:[1,0,1]
    v_cvt_pk_bf16_f32 v28, v34, v35
    v_cvt_pk_bf16_f32 v29, v36, v37
    ds_read_b128 v[16:19], v5 offset:1088
    s_waitcnt lgkmcnt(1)
    v_pk_mul_f32 v[34:35], v[20:21], v[12:13] op_sel_hi:[1,0]
    v_pk_mul_f32 v[36:37], v[22:23], v[12:13] op_sel_hi:[1,0]
    v_pk_fma_f32 v[34:35], v[96:97], v[8:9], v[34:35] op_sel_hi:[1,0,1]
    v_pk_fma_f32 v[36:37], v[98:99], v[8:9], v[36:37] op_sel_hi:[1,0,1]
    v_cvt_pk_bf16_f32 v26, v34, v35
    v_cvt_pk_bf16_f32 v27, v36, v37
    s_nop 1
    v_permlane32_swap_b32 v24, v26
    v_permlane32_swap_b32 v25, v27
    s_add_u32 s30, s46, s49
    buffer_store_dwordx4 v[24:27], v32, s[12:15], s30 offen offset:0 sc1
    v_pk_mul_f32 v[34:35], v[20:21], v[14:15] op_sel_hi:[1,0]
    v_pk_mul_f32 v[36:37], v[22:23], v[14:15] op_sel_hi:[1,0]
    v_pk_fma_f32 v[34:35], v[112:113], v[10:11], v[34:35] op_sel_hi:[1,0,1]
    v_pk_fma_f32 v[36:37], v[114:115], v[10:11], v[36:37] op_sel_hi:[1,0,1]
    v_cvt_pk_bf16_f32 v30, v34, v35
    v_cvt_pk_bf16_f32 v31, v36, v37
    s_nop 1
    v_permlane32_swap_b32 v28, v30
    v_permlane32_swap_b32 v29, v31
    s_add_u32 s30, s47, s49
    buffer_store_dwordx4 v[28:31], v32, s[12:15], s30 offen offset:0 sc1
    ds_read_b128 v[20:23], v5 offset:1120
    s_waitcnt lgkmcnt(1)
    v_pk_mul_f32 v[34:35], v[16:17], v[12:13] op_sel_hi:[1,0]
    v_pk_mul_f32 v[36:37], v[18:19], v[12:13] op_sel_hi:[1,0]
    v_pk_fma_f32 v[34:35], v[100:101], v[8:9], v[34:35] op_sel_hi:[1,0,1]
    v_pk_fma_f32 v[36:37], v[102:103], v[8:9], v[36:37] op_sel_hi:[1,0,1]
    v_cvt_pk_bf16_f32 v24, v34, v35
    v_cvt_pk_bf16_f32 v25, v36, v37
    v_pk_mul_f32 v[34:35], v[16:17], v[14:15] op_sel_hi:[1,0]
    v_pk_mul_f32 v[36:37], v[18:19], v[14:15] op_sel_hi:[1,0]
    v_pk_fma_f32 v[34:35], v[116:117], v[10:11], v[34:35] op_sel_hi:[1,0,1]
    v_pk_fma_f32 v[36:37], v[118:119], v[10:11], v[36:37] op_sel_hi:[1,0,1]
    v_cvt_pk_bf16_f32 v28, v34, v35
    v_cvt_pk_bf16_f32 v29, v36, v37
    s_waitcnt lgkmcnt(0)
    v_pk_mul_f32 v[34:35], v[20:21], v[12:13] op_sel_hi:[1,0]
    v_pk_mul_f32 v[36:37], v[22:23], v[12:13] op_sel_hi:[1,0]
    v_pk_fma_f32 v[34:35], v[104:105], v[8:9], v[34:35] op_sel_hi:[1,0,1]
    v_pk_fma_f32 v[36:37], v[106:107], v[8:9], v[36:37] op_sel_hi:[1,0,1]
    v_cvt_pk_bf16_f32 v26, v34, v35
    v_cvt_pk_bf16_f32 v27, v36, v37
    s_nop 1
    v_permlane32_swap_b32 v24, v26
    v_permlane32_swap_b32 v25, v27
    s_add_u32 s30, s46, s49
    buffer_store_dwordx4 v[24:27], v32, s[12:15], s30 offen offset:1024 sc1
    v_pk_mul_f32 v[34:35], v[20:21], v[14:15] op_sel_hi:[1,0]
    v_pk_mul_f32 v[36:37], v[22:23], v[14:15] op_sel_hi:[1,0]
    v_pk_fma_f32 v[34:35], v[120:121], v[10:11], v[34:35] op_sel_hi:[1,0,1]
    v_pk_fma_f32 v[36:37], v[122:123], v[10:11], v[36:37] op_sel_hi:[1,0,1]
    v_cvt_pk_bf16_f32 v30, v34, v35
    v_cvt_pk_bf16_f32 v31, v36, v37
    s_nop 1
    v_permlane32_swap_b32 v28, v30
    v_permlane32_swap_b32 v29, v31
    s_add_u32 s30, s47, s49
    buffer_store_dwordx4 v[28:31], v32, s[12:15], s30 offen offset:1024 sc1
    s_branch qkv_kernel_end
qkv_kernel_vpath:
    s_mov_b32 s49, 0
    s_mov_b32 s45, 0
qkv_kernel_lv:
    s_waitcnt lgkmcnt(0)
    s_barrier
    v_add_u32 v17, s45, v7
    v_add_u32 v18, s45, v8
    v_add_u32 v25, s45, v15
    v_add_u32 v26, s45, v16
    v_mfma_f32_32x32x16_bf16 v[60:75], v[36:39], v[52:55], v[60:75]
    ds_read_b128 v[28:31], v17
    ds_read_b128 v[32:35], v18
    ds_read_b64_tr_b16 v[44:45], v25 offset:0
    v_mfma_f32_32x32x16_bf16 v[76:91], v[40:43], v[52:55], v[76:91]
    ds_read_b64_tr_b16 v[46:47], v25 offset:1024
    ds_read_b64_tr_b16 v[48:49], v26 offset:0
    ds_read_b64_tr_b16 v[50:51], v26 offset:1024
    v_mfma_f32_32x32x16_bf16 v[124:139], v[52:55], v[140:143], v[124:139]
    v_add_u32 v19, s45, v9
    v_add_u32 v20, s45, v10
    v_add_u32 v21, s45, v11
    v_mfma_f32_32x32x16_bf16 v[92:107], v[36:39], v[56:59], v[92:107]
    v_add_u32 v22, s45, v12
    v_add_u32 v23, s45, v13
    v_add_u32 v24, s45, v14
    v_mfma_f32_32x32x16_bf16 v[108:123], v[40:43], v[56:59], v[108:123]
    s_waitcnt lgkmcnt(0)
    v_mfma_f32_32x32x16_bf16 v[60:75], v[28:31], v[44:47], v[60:75]
    ds_read_b128 v[36:39], v19
    ds_read_b128 v[40:43], v20
    v_mfma_f32_32x32x16_bf16 v[76:91], v[32:35], v[44:47], v[76:91]
    ds_read_b64_tr_b16 v[52:53], v25 offset:4096
    ds_read_b64_tr_b16 v[54:55], v25 offset:5120
    v_mfma_f32_32x32x16_bf16 v[124:139], v[44:47], v[140:143], v[124:139]
    ds_read_b64_tr_b16 v[56:57], v26 offset:4096
    ds_read_b64_tr_b16 v[58:59], v26 offset:5120
    v_mfma_f32_32x32x16_bf16 v[92:107], v[28:31], v[48:51], v[92:107]
    v_mfma_f32_32x32x16_bf16 v[108:123], v[32:35], v[48:51], v[108:123]
    s_waitcnt lgkmcnt(0)
    v_mfma_f32_32x32x16_bf16 v[60:75], v[36:39], v[52:55], v[60:75]
    ds_read_b128 v[28:31], v21
    ds_read_b128 v[32:35], v22
    v_mfma_f32_32x32x16_bf16 v[76:91], v[40:43], v[52:55], v[76:91]
    ds_read_b64_tr_b16 v[44:45], v25 offset:8192
    ds_read_b64_tr_b16 v[46:47], v25 offset:9216
    v_mfma_f32_32x32x16_bf16 v[124:139], v[52:55], v[140:143], v[124:139]
    ds_read_b64_tr_b16 v[48:49], v26 offset:8192
    ds_read_b64_tr_b16 v[50:51], v26 offset:9216
    v_mfma_f32_32x32x16_bf16 v[92:107], v[36:39], v[56:59], v[92:107]
    v_mfma_f32_32x32x16_bf16 v[108:123], v[40:43], v[56:59], v[108:123]
    s_waitcnt lgkmcnt(0)
    v_mfma_f32_32x32x16_bf16 v[60:75], v[28:31], v[44:47], v[60:75]
    ds_read_b128 v[36:39], v23
    ds_read_b128 v[40:43], v24
    v_mfma_f32_32x32x16_bf16 v[76:91], v[32:35], v[44:47], v[76:91]
    ds_read_b64_tr_b16 v[52:53], v25 offset:12288
    ds_read_b64_tr_b16 v[54:55], v25 offset:13312
    v_mfma_f32_32x32x16_bf16 v[124:139], v[44:47], v[140:143], v[124:139]
    ds_read_b64_tr_b16 v[56:57], v26 offset:12288
    ds_read_b64_tr_b16 v[58:59], v26 offset:13312
    v_mfma_f32_32x32x16_bf16 v[92:107], v[28:31], v[48:51], v[92:107]
    v_mfma_f32_32x32x16_bf16 v[108:123], v[32:35], v[48:51], v[108:123]
    s_add_u32 s45, s45, 32768
    s_and_b32 s45, s45, 131071
    s_add_u32 s49, s49, 1
    s_cmp_lt_u32 s49, 10
    s_cbranch_scc1 qkv_kernel_lv
    s_waitcnt lgkmcnt(0)
    v_mfma_f32_32x32x16_bf16 v[60:75], v[36:39], v[52:55], v[60:75]
    v_mfma_f32_32x32x16_bf16 v[76:91], v[40:43], v[52:55], v[76:91]
    v_mfma_f32_32x32x16_bf16 v[124:139], v[52:55], v[140:143], v[124:139]
    v_mfma_f32_32x32x16_bf16 v[92:107], v[36:39], v[56:59], v[92:107]
    v_mfma_f32_32x32x16_bf16 v[108:123], v[40:43], v[56:59], v[108:123]
    s_nop 7
    s_nop 7
    v_lshrrev_b32 v3, 5, v2
    v_lshlrev_b32 v3, 4, v3
    s_lshl_b32 s30, s20, 6
    s_lshl_b32 s31, s19, 5
    s_add_u32 s30, s30, s31
    s_lshl_b32 s30, s30, 2
    s_add_u32 s30, s30, 132096
    v_add_u32 v3, s30, v3
    s_mov_b32 s30, 1
    s_mov_b32 s31, 1
    s_mov_b64 exec, s[30:31]
    ds_write_b128 v3, v[124:127] offset:0
    ds_write_b128 v3, v[128:131] offset:32
    ds_write_b128 v3, v[132:135] offset:64
    ds_write_b128 v3, v[136:139] offset:96
    s_mov_b64 exec, -1
    s_waitcnt lgkmcnt(0)
    s_barrier
    v_and_b32 v3, 31, v2
    v_lshrrev_b32 v42, 5, v2
    s_lshl_b32 s30, s20, 6
    s_lshl_b32 s31, s19, 5
    s_add_u32 s30, s30, s31
    v_add_lshl_u32 v4, v3, s30, 2
    v_add_u32 v4, 131072, v4
    v_xor_b32 v5, 128, v4
    ds_read_b32 v7, v4 offset:1024
    ds_read_b32 v8, v5 offset:1024
    v_lshlrev_b32 v33, 4, v42
    s_lshl_b32 s30, s19, 8
    s_add_u32 s30, s30, 131072
    v_add_u32 v33, s30, v33
    s_lshl_b32 s30, s16, 3
    s_lshl_b32 s31, s19, 2
    s_add_u32 s30, s30, s31
    s_mul_i32 s30, s30, 20480
    s_sub_u32 s31, s17, 10
    s_lshl_b32 s31, s31, 7
    s_lshl_b32 s33, s20, 6
    s_add_u32 s31, s31, s33
    s_lshl_b32 s31, s31, 4
    s_add_u32 s35, s30, s31
    s_add_u32 s35, s35, 5242880
    v_mul_u32_u24 v32, 10240, v42
    v_lshl_add_u32 v32, v3, 4, v32
    s_mul_i32 s46, s20, 40960
    s_sub_u32 s47, 40960, s46
    s_add_u32 s46, s46, s35
    s_add_u32 s47, s47, s35
    s_lshl_b32 s48, s19, 9
    s_sub_u32 s49, 512, s48
    s_lshl_b32 s50, s20, 7
    s_sub_u32 s51, 128, s50
    v_add_u32 v4, s50, v33
    v_add_u32 v5, s51, v33
    s_waitcnt lgkmcnt(0)
    ds_read_b128 v[12:15], v4 offset:0
    ds_read_b128 v[20:23], v4 offset:512
    ds_read_b128 v[16:19], v4 offset:32
    ds_read_b128 v[24:27], v4 offset:544
    s_waitcnt lgkmcnt(0)
    v_mul_f32 v34, v20, v7
    v_mul_f32 v35, v21, v7
    v_mul_f32 v36, v22, v7
    v_mul_f32 v37, v23, v7
    v_fmac_f32 v34, v60, v12
    v_fmac_f32 v35, v61, v13
    v_fmac_f32 v36, v62, v14
    v_fmac_f32 v37, v63, v15
    v_mul_f32 v38, v24, v7
    v_mul_f32 v39, v25, v7
    v_mul_f32 v40, v26, v7
    v_mul_f32 v41, v27, v7
    v_fmac_f32 v38, v64, v16
    v_fmac_f32 v39, v65, v17
    v_fmac_f32 v40, v66, v18
    v_fmac_f32 v41, v67, v19
    v_cvt_pk_bf16_f32 v28, v34, v35
    v_cvt_pk_bf16_f32 v29, v36, v37
    v_cvt_pk_bf16_f32 v30, v38, v39
    v_cvt_pk_bf16_f32 v31, v40, v41
    s_add_u32 s30, s46, s48
    s_add_u32 s30, s30, 0
    buffer_store_dwordx4 v[28:31], v32, s[12:15], s30 offen sc1
    s_nop 1
    v_mul_f32 v34, v20, v8
    v_mul_f32 v35, v21, v8
    v_mul_f32 v36, v22, v8
    v_mul_f32 v37, v23, v8
    v_fmac_f32 v34, v92, v12
    v_fmac_f32 v35, v93, v13
    v_fmac_f32 v36, v94, v14
    v_fmac_f32 v37, v95, v15
    v_mul_f32 v38, v24, v8
    v_mul_f32 v39, v25, v8
    v_mul_f32 v40, v26, v8
    v_mul_f32 v41, v27, v8
    v_fmac_f32 v38, v96, v16
    v_fmac_f32 v39, v97, v17
    v_fmac_f32 v40, v98, v18
    v_fmac_f32 v41, v99, v19
    v_cvt_pk_bf16_f32 v28, v34, v35
    v_cvt_pk_bf16_f32 v29, v36, v37
    v_cvt_pk_bf16_f32 v30, v38, v39
    v_cvt_pk_bf16_f32 v31, v40, v41
    s_add_u32 s30, s46, s49
    s_add_u32 s30, s30, 0
    buffer_store_dwordx4 v[28:31], v32, s[12:15], s30 offen sc1
    s_nop 1
    ds_read_b128 v[12:15], v4 offset:64
    ds_read_b128 v[20:23], v4 offset:576
    ds_read_b128 v[16:19], v4 offset:96
    ds_read_b128 v[24:27], v4 offset:608
    s_waitcnt lgkmcnt(0)
    v_mul_f32 v34, v20, v7
    v_mul_f32 v35, v21, v7
    v_mul_f32 v36, v22, v7
    v_mul_f32 v37, v23, v7
    v_fmac_f32 v34, v68, v12
    v_fmac_f32 v35, v69, v13
    v_fmac_f32 v36, v70, v14
    v_fmac_f32 v37, v71, v15
    v_mul_f32 v38, v24, v7
    v_mul_f32 v39, v25, v7
    v_mul_f32 v40, v26, v7
    v_mul_f32 v41, v27, v7
    v_fmac_f32 v38, v72, v16
    v_fmac_f32 v39, v73, v17
    v_fmac_f32 v40, v74, v18
    v_fmac_f32 v41, v75, v19
    v_cvt_pk_bf16_f32 v28, v34, v35
    v_cvt_pk_bf16_f32 v29, v36, v37
    v_cvt_pk_bf16_f32 v30, v38, v39
    v_cvt_pk_bf16_f32 v31, v40, v41
    s_add_u32 s30, s46, s48
    s_add_u32 s30, s30, 20480
    buffer_store_dwordx4 v[28:31], v32, s[12:15], s30 offen sc1
    s_nop 1
    v_mul_f32 v34, v20, v8
    v_mul_f32 v35, v21, v8
    v_mul_f32 v36, v22, v8
    v_mul_f32 v37, v23, v8
    v_fmac_f32 v34, v100, v12
    v_fmac_f32 v35, v101, v13
    v_fmac_f32 v36, v102, v14
    v_fmac_f32 v37, v103, v15
    v_mul_f32 v38, v24, v8
    v_mul_f32 v39, v25, v8
    v_mul_f32 v40, v26, v8
    v_mul_f32 v41, v27, v8
    v_fmac_f32 v38, v104, v16
    v_fmac_f32 v39, v105, v17
    v_fmac_f32 v40, v106, v18
    v_fmac_f32 v41, v107, v19
    v_cvt_pk_bf16_f32 v28, v34, v35
    v_cvt_pk_bf16_f32 v29, v36, v37
    v_cvt_pk_bf16_f32 v30, v38, v39
    v_cvt_pk_bf16_f32 v31, v40, v41
    s_add_u32 s30, s46, s49
    s_add_u32 s30, s30, 20480
    buffer_store_dwordx4 v[28:31], v32, s[12:15], s30 offen sc1
    s_nop 1
    ds_read_b128 v[12:15], v5 offset:0
    ds_read_b128 v[20:23], v5 offset:512
    ds_read_b128 v[16:19], v5 offset:32
    ds_read_b128 v[24:27], v5 offset:544
    s_waitcnt lgkmcnt(0)
    v_mul_f32 v34, v20, v7
    v_mul_f32 v35, v21, v7
    v_mul_f32 v36, v22, v7
    v_mul_f32 v37, v23, v7
    v_fmac_f32 v34, v76, v12
    v_fmac_f32 v35, v77, v13
    v_fmac_f32 v36, v78, v14
    v_fmac_f32 v37, v79, v15
    v_mul_f32 v38, v24, v7
    v_mul_f32 v39, v25, v7
    v_mul_f32 v40, v26, v7
    v_mul_f32 v41, v27, v7
    v_fmac_f32 v38, v80, v16
    v_fmac_f32 v39, v81, v17
    v_fmac_f32 v40, v82, v18
    v_fmac_f32 v41, v83, v19
    v_cvt_pk_bf16_f32 v28, v34, v35
    v_cvt_pk_bf16_f32 v29, v36, v37
    v_cvt_pk_bf16_f32 v30, v38, v39
    v_cvt_pk_bf16_f32 v31, v40, v41
    s_add_u32 s30, s47, s48
    s_add_u32 s30, s30, 0
    buffer_store_dwordx4 v[28:31], v32, s[12:15], s30 offen sc1
    s_nop 1
    v_mul_f32 v34, v20, v8
    v_mul_f32 v35, v21, v8
    v_mul_f32 v36, v22, v8
    v_mul_f32 v37, v23, v8
    v_fmac_f32 v34, v108, v12
    v_fmac_f32 v35, v109, v13
    v_fmac_f32 v36, v110, v14
    v_fmac_f32 v37, v111, v15
    v_mul_f32 v38, v24, v8
    v_mul_f32 v39, v25, v8
    v_mul_f32 v40, v26, v8
    v_mul_f32 v41, v27, v8
    v_fmac_f32 v38, v112, v16
    v_fmac_f32 v39, v113, v17
    v_fmac_f32 v40, v114, v18
    v_fmac_f32 v41, v115, v19
    v_cvt_pk_bf16_f32 v28, v34, v35
    v_cvt_pk_bf16_f32 v29, v36, v37
    v_cvt_pk_bf16_f32 v30, v38, v39
    v_cvt_pk_bf16_f32 v31, v40, v41
    s_add_u32 s30, s47, s49
    s_add_u32 s30, s30, 0
    buffer_store_dwordx4 v[28:31], v32, s[12:15], s30 offen sc1
    s_nop 1
    ds_read_b128 v[12:15], v5 offset:64
    ds_read_b128 v[20:23], v5 offset:576
    ds_read_b128 v[16:19], v5 offset:96
    ds_read_b128 v[24:27], v5 offset:608
    s_waitcnt lgkmcnt(0)
    v_mul_f32 v34, v20, v7
    v_mul_f32 v35, v21, v7
    v_mul_f32 v36, v22, v7
    v_mul_f32 v37, v23, v7
    v_fmac_f32 v34, v84, v12
    v_fmac_f32 v35, v85, v13
    v_fmac_f32 v36, v86, v14
    v_fmac_f32 v37, v87, v15
    v_mul_f32 v38, v24, v7
    v_mul_f32 v39, v25, v7
    v_mul_f32 v40, v26, v7
    v_mul_f32 v41, v27, v7
    v_fmac_f32 v38, v88, v16
    v_fmac_f32 v39, v89, v17
    v_fmac_f32 v40, v90, v18
    v_fmac_f32 v41, v91, v19
    v_cvt_pk_bf16_f32 v28, v34, v35
    v_cvt_pk_bf16_f32 v29, v36, v37
    v_cvt_pk_bf16_f32 v30, v38, v39
    v_cvt_pk_bf16_f32 v31, v40, v41
    s_add_u32 s30, s47, s48
    s_add_u32 s30, s30, 20480
    buffer_store_dwordx4 v[28:31], v32, s[12:15], s30 offen sc1
    s_nop 1
    v_mul_f32 v34, v20, v8
    v_mul_f32 v35, v21, v8
    v_mul_f32 v36, v22, v8
    v_mul_f32 v37, v23, v8
    v_fmac_f32 v34, v116, v12
    v_fmac_f32 v35, v117, v13
    v_fmac_f32 v36, v118, v14
    v_fmac_f32 v37, v119, v15
    v_mul_f32 v38, v24, v8
    v_mul_f32 v39, v25, v8
    v_mul_f32 v40, v26, v8
    v_mul_f32 v41, v27, v8
    v_fmac_f32 v38, v120, v16
    v_fmac_f32 v39, v121, v17
    v_fmac_f32 v40, v122, v18
    v_fmac_f32 v41, v123, v19
    v_cvt_pk_bf16_f32 v28, v34, v35
    v_cvt_pk_bf16_f32 v29, v36, v37
    v_cvt_pk_bf16_f32 v30, v38, v39
    v_cvt_pk_bf16_f32 v31, v40, v41
    s_add_u32 s30, s47, s49
    s_add_u32 s30, s30, 20480
    buffer_store_dwordx4 v[28:31], v32, s[12:15], s30 offen sc1
    s_nop 1
    s_branch qkv_kernel_end
qkv_kernel_stats:
    s_sub_u32 s18, s18, 8
    s_lshl_b32 s23, s18, 12
    v_and_b32 v3, 31, v2
    v_lshrrev_b32 v4, 5, v2
    v_lshlrev_b32 v4, 2, v4
    v_bfe_u32 v5, v3, 1, 3
    v_xor_b32 v5, v5, v4
    v_lshlrev_b32 v5, 4, v5
    v_lshl_add_u32 v5, v3, 7, v5
    v_add_u32 v5, s23, v5
    v_xor_b32 v6, 0, v5
    v_xor_b32 v7, 16, v5
    v_xor_b32 v8, 32, v5
    v_xor_b32 v9, 48, v5
    v_mov_b32 v32, 0
    v_mov_b32 v33, 0
    v_mov_b32 v34, 0
    v_mov_b32 v35, 0
    s_mov_b32 s49, 0
    s_mov_b32 s45, 0
qkv_kernel_sloop:
    s_barrier
    v_add_u32 v10, s45, v6
    v_add_u32 v11, s45, v7
    v_add_u32 v12, s45, v8
    v_add_u32 v13, s45, v9
    ds_read_b128 v[16:19], v10
    ds_read_b128 v[20:23], v11
    ds_read_b128 v[24:27], v12
    ds_read_b128 v[28:31], v13
    s_waitcnt lgkmcnt(3)
    v_lshlrev_b32 v36, 16, v16
    v_and_b32 v37, 0xffff0000, v16
    v_lshlrev_b32 v38, 16, v17
    v_and_b32 v39, 0xffff0000, v17
    v_add_f32 v32, v32, v36
    v_fmac_f32 v34, v36, v36
    v_add_f32 v33, v33, v37
    v_fmac_f32 v35, v37, v37
    v_add_f32 v32, v32, v38
    v_fmac_f32 v34, v38, v38
    v_add_f32 v33, v33, v39
    v_fmac_f32 v35, v39, v39
    v_lshlrev_b32 v36, 16, v18
    v_and_b32 v37, 0xffff0000, v18
    v_lshlrev_b32 v38, 16, v19
    v_and_b32 v39, 0xffff0000, v19
    v_add_f32 v32, v32, v36
    v_fmac_f32 v34, v36, v36
    v_add_f32 v33, v33, v37
    v_fmac_f32 v35, v37, v37
    v_add_f32 v32, v32, v38
    v_fmac_f32 v34, v38, v38
    v_add_f32 v33, v33, v39
    v_fmac_f32 v35, v39, v39
    s_waitcnt lgkmcnt(2)
    v_lshlrev_b32 v36, 16, v20
    v_and_b32 v37, 0xffff0000, v20
    v_lshlrev_b32 v38, 16, v21
    v_and_b32 v39, 0xffff0000, v21
    v_add_f32 v32, v32, v36
    v_fmac_f32 v34, v36, v36
    v_add_f32 v33, v33, v37
    v_fmac_f32 v35, v37, v37
    v_add_f32 v32, v32, v38
    v_fmac_f32 v34, v38, v38
    v_add_f32 v33, v33, v39
    v_fmac_f32 v35, v39, v39
    v_lshlrev_b32 v36, 16, v22
    v_and_b32 v37, 0xffff0000, v22
    v_lshlrev_b32 v38, 16, v23
    v_and_b32 v39, 0xffff0000, v23
    v_add_f32 v32, v32, v36
    v_fmac_f32 v34, v36, v36
    v_add_f32 v33, v33, v37
    v_fmac_f32 v35, v37, v37
    v_add_f32 v32, v32, v38
    v_fmac_f32 v34, v38, v38
    v_add_f32 v33, v33, v39
    v_fmac_f32 v35, v39, v39
    s_waitcnt lgkmcnt(1)
    v_lshlrev_b32 v36, 16, v24
    v_and_b32 v37, 0xffff0000, v24
    v_lshlrev_b32 v38, 16, v25
    v_and_b32 v39, 0xffff0000, v25
    v_add_f32 v32, v32, v36
    v_fmac_f32 v34, v36, v36
    v_add_f32 v33, v33, v37
    v_fmac_f32 v35, v37, v37
    v_add_f32 v32, v32, v38
    v_fmac_f32 v34, v38, v38
    v_add_f32 v33, v33, v39
    v_fmac_f32 v35, v39, v39
    v_lshlrev_b32 v36, 16, v26
    v_and_b32 v37, 0xffff0000, v26
    v_lshlrev_b32 v38, 16, v27
    v_and_b32 v39, 0xffff0000, v27
    v_add_f32 v32, v32, v36
    v_fmac_f32 v34, v36, v36
    v_add_f32 v33, v33, v37
    v_fmac_f32 v35, v37, v37
    v_add_f32 v32, v32, v38
    v_fmac_f32 v34, v38, v38
    v_add_f32 v33, v33, v39
    v_fmac_f32 v35, v39, v39
    s_waitcnt lgkmcnt(0)
    v_lshlrev_b32 v36, 16, v28
    v_and_b32 v37, 0xffff0000, v28
    v_lshlrev_b32 v38, 16, v29
    v_and_b32 v39, 0xffff0000, v29
    v_add_f32 v32, v32, v36
    v_fmac_f32 v34, v36, v36
    v_add_f32 v33, v33, v37
    v_fmac_f32 v35, v37, v37
    v_add_f32 v32, v32, v38
    v_fmac_f32 v34, v38, v38
    v_add_f32 v33, v33, v39
    v_fmac_f32 v35, v39, v39
    v_lshlrev_b32 v36, 16, v30
    v_and_b32 v37, 0xffff0000, v30
    v_lshlrev_b32 v38, 16, v31
    v_and_b32 v39, 0xffff0000, v31
    v_add_f32 v32, v32, v36
    v_fmac_f32 v34, v36, v36
    v_add_f32 v33, v33, v37
    v_fmac_f32 v35, v37, v37
    v_add_f32 v32, v32, v38
    v_fmac_f32 v34, v38, v38
    v_add_f32 v33, v33, v39
    v_fmac_f32 v35, v39, v39
    s_add_u32 s45, s45, 32768
    s_and_b32 s45, s45, 131071
    s_add_u32 s49, s49, 1
    s_cmp_lt_u32 s49, 10
    s_cbranch_scc1 qkv_kernel_sloop
    v_add_f32 v32, v32, v33
    v_add_f32 v34, v34, v35
    v_mov_b32 v36, v32
    v_mov_b32 v37, v34
    s_nop 1
    v_permlane32_swap_b32 v36, v32
    v_permlane32_swap_b32 v37, v34
    s_nop 1
    v_add_f32 v32, v32, v36
    v_add_f32 v34, v34, v37
    s_mov_b32 s30, 986500301
    v_mul_f32 v32, s30, v32
    v_mul_f32 v34, s30, v34
    v_fma_f32 v34, -v32, v32, v34
    v_max_f32 v34, 0, v34
    v_add_f32 v34, 925353388, v34
    v_rsq_f32 v34, v34
    s_nop 0
    v_mul_f32 v32, v32, v34
    v_sub_f32 v32, 0, v32
    v_and_b32 v3, 31, v2
    s_lshl_b32 s30, s18, 7
    s_add_u32 s30, s30, 131072
    v_lshlrev_b32 v3, 2, v3
    v_add_u32 v3, s30, v3
    ds_write_b32 v3, v34
    ds_write_b32 v3, v32 offset:512
    s_waitcnt lgkmcnt(0)
    s_barrier
    s_branch qkv_kernel_end
qkv_kernel_colsum:
    s_cmp_ge_u32 s18, 8
    s_cbranch_scc1 qkv_kernel_csb
    s_sub_u32 s30, s2, 240
    s_lshr_b32 s31, s30, 3
    s_and_b32 s32, s30, 7
    s_waitcnt lgkmcnt(0)
    s_cmp_eq_u32 s31, 0
    s_cselect_b32 s4, s72, s74
    s_cselect_b32 s5, s73, s75
    s_mov_b32 s6, 2211840
    s_mov_b32 s7, 0x00020000
    s_add_u32 s12, s82, 20185088
    s_addc_u32 s13, s83, 0
    s_mov_b32 s14, 13824
    s_mov_b32 s15, 0x00020000
    v_and_b32 v3, 31, v0
    v_lshrrev_b32 v4, 5, v0
    v_mul_u32_u24 v5, 138240, v4
    v_lshl_add_u32 v5, v3, 4, v5
    s_mul_i32 s33, s32, 432
    s_mov_b32 s46, 0x00003f80
    s_mov_b32 s47, 0x3f800000
    s_mov_b32 s49, 0
    v_mov_b32 v8, 0
    v_mov_b32 v9, 0
    v_mov_b32 v10, 0
    v_mov_b32 v11, 0
    v_mov_b32 v12, 0
    v_mov_b32 v13, 0
    v_mov_b32 v14, 0
    v_mov_b32 v15, 0
qkv_kernel_csl:
    s_add_u32 s30, s33, 0
    buffer_load_dwordx4 v[16:19], v5, s[4:7], s30 offen
    s_add_u32 s30, s33, 3456
    buffer_load_dwordx4 v[20:23], v5, s[4:7], s30 offen
    s_add_u32 s30, s33, 6912
    buffer_load_dwordx4 v[24:27], v5, s[4:7], s30 offen
    s_add_u32 s30, s33, 10368
    buffer_load_dwordx4 v[28:31], v5, s[4:7], s30 offen
    s_add_u32 s30, s33, 13824
    buffer_load_dwordx4 v[32:35], v5, s[4:7], s30 offen
    s_add_u32 s30, s33, 17280
    buffer_load_dwordx4 v[36:39], v5, s[4:7], s30 offen
    s_add_u32 s30, s33, 20736
    buffer_load_dwordx4 v[40:43], v5, s[4:7], s30 offen
    s_add_u32 s30, s33, 24192
    buffer_load_dwordx4 v[44:47], v5, s[4:7], s30 offen
    s_add_u32 s30, s33, 27648
    buffer_load_dwordx4 v[48:51], v5, s[4:7], s30 offen
    s_add_u32 s30, s33, 31104
    buffer_load_dwordx4 v[52:55], v5, s[4:7], s30 offen
    s_add_u32 s30, s33, 34560
    buffer_load_dwordx4 v[56:59], v5, s[4:7], s30 offen
    s_add_u32 s30, s33, 38016
    buffer_load_dwordx4 v[60:63], v5, s[4:7], s30 offen
    s_add_u32 s30, s33, 41472
    buffer_load_dwordx4 v[64:67], v5, s[4:7], s30 offen
    s_add_u32 s30, s33, 44928
    buffer_load_dwordx4 v[68:71], v5, s[4:7], s30 offen
    s_add_u32 s30, s33, 48384
    buffer_load_dwordx4 v[72:75], v5, s[4:7], s30 offen
    s_add_u32 s30, s33, 51840
    buffer_load_dwordx4 v[76:79], v5, s[4:7], s30 offen
    s_add_u32 s30, s33, 55296
    buffer_load_dwordx4 v[80:83], v5, s[4:7], s30 offen
    s_add_u32 s30, s33, 58752
    buffer_load_dwordx4 v[84:87], v5, s[4:7], s30 offen
    s_add_u32 s30, s33, 62208
    buffer_load_dwordx4 v[88:91], v5, s[4:7], s30 offen
    s_add_u32 s30, s33, 65664
    buffer_load_dwordx4 v[92:95], v5, s[4:7], s30 offen
    s_waitcnt vmcnt(19)
    v_dot2c_f32_bf16 v8, s46, v16
    v_dot2c_f32_bf16 v9, s47, v16
    v_dot2c_f32_bf16 v10, s46, v17
    v_dot2c_f32_bf16 v11, s47, v17
    v_dot2c_f32_bf16 v12, s46, v18
    v_dot2c_f32_bf16 v13, s47, v18
    v_dot2c_f32_bf16 v14, s46, v19
    v_dot2c_f32_bf16 v15, s47, v19
    s_waitcnt vmcnt(18)
    v_dot2c_f32_bf16 v8, s46, v20
    v_dot2c_f32_bf16 v9, s47, v20
    v_dot2c_f32_bf16 v10, s46, v21
    v_dot2c_f32_bf16 v11, s47, v21
    v_dot2c_f32_bf16 v12, s46, v22
    v_dot2c_f32_bf16 v13, s47, v22
    v_dot2c_f32_bf16 v14, s46, v23
    v_dot2c_f32_bf16 v15, s47, v23
    s_waitcnt vmcnt(17)
    v_dot2c_f32_bf16 v8, s46, v24
    v_dot2c_f32_bf16 v9, s47, v24
    v_dot2c_f32_bf16 v10, s46, v25
    v_dot2c_f32_bf16 v11, s47, v25
    v_dot2c_f32_bf16 v12, s46, v26
    v_dot2c_f32_bf16 v13, s47, v26
    v_dot2c_f32_bf16 v14, s46, v27
    v_dot2c_f32_bf16 v15, s47, v27
    s_waitcnt vmcnt(16)
    v_dot2c_f32_bf16 v8, s46, v28
    v_dot2c_f32_bf16 v9, s47, v28
    v_dot2c_f32_bf16 v10, s46, v29
    v_dot2c_f32_bf16 v11, s47, v29
    v_dot2c_f32_bf16 v12, s46, v30
    v_dot2c_f32_bf16 v13, s47, v30
    v_dot2c_f32_bf16 v14, s46, v31
    v_dot2c_f32_bf16 v15, s47, v31
    s_waitcnt vmcnt(15)
    v_dot2c_f32_bf16 v8, s46, v32
    v_dot2c_f32_bf16 v9, s47, v32
    v_dot2c_f32_bf16 v10, s46, v33
    v_dot2c_f32_bf16 v11, s47, v33
    v_dot2c_f32_bf16 v12, s46, v34
    v_dot2c_f32_bf16 v13, s47, v34
    v_dot2c_f32_bf16 v14, s46, v35
    v_dot2c_f32_bf16 v15, s47, v35
    s_waitcnt vmcnt(14)
    v_dot2c_f32_bf16 v8, s46, v36
    v_dot2c_f32_bf16 v9, s47, v36
    v_dot2c_f32_bf16 v10, s46, v37
    v_dot2c_f32_bf16 v11, s47, v37
    v_dot2c_f32_bf16 v12, s46, v38
    v_dot2c_f32_bf16 v13, s47, v38
    v_dot2c_f32_bf16 v14, s46, v39
    v_dot2c_f32_bf16 v15, s47, v39
    s_waitcnt vmcnt(13)
    v_dot2c_f32_bf16 v8, s46, v40
    v_dot2c_f32_bf16 v9, s47, v40
    v_dot2c_f32_bf16 v10, s46, v41
    v_dot2c_f32_bf16 v11, s47, v41
    v_dot2c_f32_bf16 v12, s46, v42
    v_dot2c_f32_bf16 v13, s47, v42
    v_dot2c_f32_bf16 v14, s46, v43
    v_dot2c_f32_bf16 v15, s47, v43
    s_waitcnt vmcnt(12)
    v_dot2c_f32_bf16 v8, s46, v44
    v_dot2c_f32_bf16 v9, s47, v44
    v_dot2c_f32_bf16 v10, s46, v45
    v_dot2c_f32_bf16 v11, s47, v45
    v_dot2c_f32_bf16 v12, s46, v46
    v_dot2c_f32_bf16 v13, s47, v46
    v_dot2c_f32_bf16 v14, s46, v47
    v_dot2c_f32_bf16 v15, s47, v47
    s_waitcnt vmcnt(11)
    v_dot2c_f32_bf16 v8, s46, v48
    v_dot2c_f32_bf16 v9, s47, v48
    v_dot2c_f32_bf16 v10, s46, v49
    v_dot2c_f32_bf16 v11, s47, v49
    v_dot2c_f32_bf16 v12, s46, v50
    v_dot2c_f32_bf16 v13, s47, v50
    v_dot2c_f32_bf16 v14, s46, v51
    v_dot2c_f32_bf16 v15, s47, v51
    s_waitcnt vmcnt(10)
    v_dot2c_f32_bf16 v8, s46, v52
    v_dot2c_f32_bf16 v9, s47, v52
    v_dot2c_f32_bf16 v10, s46, v53
    v_dot2c_f32_bf16 v11, s47, v53
    v_dot2c_f32_bf16 v12, s46, v54
    v_dot2c_f32_bf16 v13, s47, v54
    v_dot2c_f32_bf16 v14, s46, v55
    v_dot2c_f32_bf16 v15, s47, v55
    s_waitcnt vmcnt(9)
    v_dot2c_f32_bf16 v8, s46, v56
    v_dot2c_f32_bf16 v9, s47, v56
    v_dot2c_f32_bf16 v10, s46, v57
    v_dot2c_f32_bf16 v11, s47, v57
    v_dot2c_f32_bf16 v12, s46, v58
    v_dot2c_f32_bf16 v13, s47, v58
    v_dot2c_f32_bf16 v14, s46, v59
    v_dot2c_f32_bf16 v15, s47, v59
    s_waitcnt vmcnt(8)
    v_dot2c_f32_bf16 v8, s46, v60
    v_dot2c_f32_bf16 v9, s47, v60
    v_dot2c_f32_bf16 v10, s46, v61
    v_dot2c_f32_bf16 v11, s47, v61
    v_dot2c_f32_bf16 v12, s46, v62
    v_dot2c_f32_bf16 v13, s47, v62
    v_dot2c_f32_bf16 v14, s46, v63
    v_dot2c_f32_bf16 v15, s47, v63
    s_waitcnt vmcnt(7)
    v_dot2c_f32_bf16 v8, s46, v64
    v_dot2c_f32_bf16 v9, s47, v64
    v_dot2c_f32_bf16 v10, s46, v65
    v_dot2c_f32_bf16 v11, s47, v65
    v_dot2c_f32_bf16 v12, s46, v66
    v_dot2c_f32_bf16 v13, s47, v66
    v_dot2c_f32_bf16 v14, s46, v67
    v_dot2c_f32_bf16 v15, s47, v67
    s_waitcnt vmcnt(6)
    v_dot2c_f32_bf16 v8, s46, v68
    v_dot2c_f32_bf16 v9, s47, v68
    v_dot2c_f32_bf16 v10, s46, v69
    v_dot2c_f32_bf16 v11, s47, v69
    v_dot2c_f32_bf16 v12, s46, v70
    v_dot2c_f32_bf16 v13, s47, v70
    v_dot2c_f32_bf16 v14, s46, v71
    v_dot2c_f32_bf16 v15, s47, v71
    s_waitcnt vmcnt(5)
    v_dot2c_f32_bf16 v8, s46, v72
    v_dot2c_f32_bf16 v9, s47, v72
    v_dot2c_f32_bf16 v10, s46, v73
    v_dot2c_f32_bf16 v11, s47, v73
    v_dot2c_f32_bf16 v12, s46, v74
    v_dot2c_f32_bf16 v13, s47, v74
    v_dot2c_f32_bf16 v14, s46, v75
    v_dot2c_f32_bf16 v15, s47, v75
    s_waitcnt vmcnt(4)
    v_dot2c_f32_bf16 v8, s46, v76
    v_dot2c_f32_bf16 v9, s47, v76
    v_dot2c_f32_bf16 v10, s46, v77
    v_dot2c_f32_bf16 v11, s47, v77
    v_dot2c_f32_bf16 v12, s46, v78
    v_dot2c_f32_bf16 v13, s47, v78
    v_dot2c_f32_bf16 v14, s46, v79
    v_dot2c_f32_bf16 v15, s47, v79
    s_waitcnt vmcnt(3)
    v_dot2c_f32_bf16 v8, s46, v80
    v_dot2c_f32_bf16 v9, s47, v80
    v_dot2c_f32_bf16 v10, s46, v81
    v_dot2c_f32_bf16 v11, s47, v81
    v_dot2c_f32_bf16 v12, s46, v82
    v_dot2c_f32_bf16 v13, s47, v82
    v_dot2c_f32_bf16 v14, s46, v83
    v_dot2c_f32_bf16 v15, s47, v83
    s_waitcnt vmcnt(2)
    v_dot2c_f32_bf16 v8, s46, v84
    v_dot2c_f32_bf16 v9, s47, v84
    v_dot2c_f32_bf16 v10, s46, v85
    v_dot2c_f32_bf16 v11, s47, v85
    v_dot2c_f32_bf16 v12, s46, v86
    v_dot2c_f32_bf16 v13, s47, v86
    v_dot2c_f32_bf16 v14, s46, v87
    v_dot2c_f32_bf16 v15, s47, v87
    s_waitcnt vmcnt(1)
    v_dot2c_f32_bf16 v8, s46, v88
    v_dot2c_f32_bf16 v9, s47, v88
    v_dot2c_f32_bf16 v10, s46, v89
    v_dot2c_f32_bf16 v11, s47, v89
    v_dot2c_f32_bf16 v12, s46, v90
    v_dot2c_f32_bf16 v13, s47, v90
    v_dot2c_f32_bf16 v14, s46, v91
    v_dot2c_f32_bf16 v15, s47, v91
    s_waitcnt vmcnt(0)
    v_dot2c_f32_bf16 v8, s46, v92
    v_dot2c_f32_bf16 v9, s47, v92
    v_dot2c_f32_bf16 v10, s46, v93
    v_dot2c_f32_bf16 v11, s47, v93
    v_dot2c_f32_bf16 v12, s46, v94
    v_dot2c_f32_bf16 v13, s47, v94
    v_dot2c_f32_bf16 v14, s46, v95
    v_dot2c_f32_bf16 v15, s47, v95
    s_add_u32 s33, s33, 69120
    s_add_u32 s49, s49, 1
    s_cmp_lt_u32 s49, 2
    s_cbranch_scc1 qkv_kernel_csl
    s_nop 3
    v_lshlrev_b32 v4, 5, v0
    ds_write_b128 v4, v[8:11]
    ds_write_b128 v4, v[12:15] offset:16
    s_waitcnt lgkmcnt(0)
    s_barrier
    v_lshlrev_b32 v4, 2, v0
    ds_read_b32 v16, v4 offset:0
    ds_read_b32 v17, v4 offset:1024
    ds_read_b32 v18, v4 offset:2048
    ds_read_b32 v19, v4 offset:3072
    ds_read_b32 v20, v4 offset:4096
    ds_read_b32 v21, v4 offset:5120
    ds_read_b32 v22, v4 offset:6144
    ds_read_b32 v23, v4 offset:7168
    ds_read_b32 v24, v4 offset:8192
    ds_read_b32 v25, v4 offset:9216
    ds_read_b32 v26, v4 offset:10240
    ds_read_b32 v27, v4 offset:11264
    ds_read_b32 v28, v4 offset:12288
    ds_read_b32 v29, v4 offset:13312
    ds_read_b32 v30, v4 offset:14336
    ds_read_b32 v31, v4 offset:15360
    s_waitcnt lgkmcnt(0)
    v_add_f32 v16, v16, v17
    v_add_f32 v16, v16, v18
    v_add_f32 v16, v16, v19
    v_add_f32 v16, v16, v20
    v_add_f32 v16, v16, v21
    v_add_f32 v16, v16, v22
    v_add_f32 v16, v16, v23
    v_add_f32 v16, v16, v24
    v_add_f32 v16, v16, v25
    v_add_f32 v16, v16, v26
    v_add_f32 v16, v16, v27
    v_add_f32 v16, v16, v28
    v_add_f32 v16, v16, v29
    v_add_f32 v16, v16, v30
    v_add_f32 v16, v16, v31
    s_mul_i32 s30, s31, 6912
    s_mul_i32 s33, s32, 864
    s_add_u32 s30, s30, s33
    v_cmp_gt_u32 vcc, 216, v0
    s_and_saveexec_b64 s[34:35], vcc
    s_cbranch_execz qkv_kernel_end
    buffer_store_dword v16, v4, s[12:15], s30 offen
    s_branch qkv_kernel_end
qkv_kernel_csb:
qkv_kernel_csb2:
    s_barrier
qkv_kernel_end:
    s_endpgm
.globl attn_kernel
.p2align 8
.type attn_kernel,@function
attn_kernel:
    s_cmp_ge_u32 s2, 256
    s_cbranch_scc1 attn_kernel_end
    s_load_dwordx16 s[64:79], s[0:1], 0
    s_load_dwordx4 s[80:83], s[0:1], 64
    v_lshrrev_b32 v1, 6, v0
    v_and_b32 v2, 63, v0
    v_readfirstlane_b32 s18, v1
    s_and_b32 s30, s2, 7
    s_lshr_b32 s31, s2, 3
    s_lshr_b32 s32, s31, 3
    s_lshl_b32 s16, s30, 2
    s_add_u32 s16, s16, s32
    s_and_b32 s17, s31, 7
    s_cmp_ge_u32 s18, 8
    s_cbranch_scc0 attn_kernel_main_svc
    v_lshlrev_b32 v3, 4, v2
    v_lshrrev_b32 v6, 5, v2
    v_mul_u32_u24 v6, 40960, v6
    v_and_b32 v7, 31, v2
    v_lshl_add_u32 v4, v7, 4, v6
    v_mul_u32_u24 v6, 49, v2
    v_lshrrev_b32 v6, 10, v6
    v_mul_u32_u24 v7, 21, v6
    v_sub_u32 v7, v2, v7
    v_cmp_gt_u32 vcc, 20, v7
    v_cmp_gt_u32 s[30:31], 63, v2
    v_mul_u32_u24 v6, 10240, v6
    v_lshl_add_u32 v5, v7, 4, v6
    s_and_b64 s[56:57], vcc, s[30:31]
    s_mul_i32 s50, s16, 5
    s_add_u32 s50, s50, 1
    s_lshr_b32 s50, s50, 1
    s_lshl_b32 s50, s50, 9
    s_and_b32 s58, s16, 1
    s_mul_i32 s58, s58, 4294965760
    s_add_u32 s58, s58, 1024
    s_add_u32 s58, s58, s50
    s_mul_i32 s51, s16, 320
    s_add_u32 s51, s51, 2621440
    s_waitcnt lgkmcnt(0)
    s_add_u32 s4, s82, 2621440
    s_addc_u32 s5, s83, 0
    s_mov_b32 s6, 5242880
    s_mov_b32 s7, 0x00020000
    s_sub_u32 s19, s18, 8
    s_mov_b32 s20, 0
    s_mov_b32 s21, 0
    s_cmp_ge_u32 s19, 2
    s_cbranch_scc1 attn_kernel_iv_2
    s_mul_i32 s30, s19, 163840
    s_add_u32 s30, s30, s21
    s_add_u32 s30, s30, s50
    s_lshl_b32 s32, s19, 12
    s_add_u32 s32, s32, s20
    s_add_u32 m0, s32, 0
    s_add_u32 s31, s30, 0
    buffer_load_dwordx4 v3, s[4:7], s31 offen lds
    s_add_u32 m0, s32, 1024
    s_add_u32 s31, s30, 40960
    buffer_load_dwordx4 v3, s[4:7], s31 offen lds
    s_add_u32 m0, s32, 2048
    s_add_u32 s31, s30, 81920
    buffer_load_dwordx4 v3, s[4:7], s31 offen lds
    s_add_u32 m0, s32, 3072
    s_add_u32 s31, s30, 122880
    buffer_load_dwordx4 v3, s[4:7], s31 offen lds
    s_mul_i32 s30, s19, 163840
    s_add_u32 s30, s30, s21
    s_add_u32 s30, s30, s58
    s_lshl_b32 s32, s19, 11
    s_add_u32 s32, s32, s20
    s_add_u32 m0, s32, 8192
    s_add_u32 s31, s30, 0
    buffer_load_dwordx4 v4, s[4:7], s31 offen lds
    s_add_u32 m0, s32, 9216
    s_add_u32 s31, s30, 81920
    buffer_load_dwordx4 v4, s[4:7], s31 offen lds
    s_branch attn_kernel_ie_3
attn_kernel_iv_2:
    s_sub_u32 s32, s19, 2
    s_mul_i32 s30, s32, 184320
    s_add_u32 s30, s30, s21
    s_add_u32 s30, s30, s51
    s_mul_i32 s32, s32, 6048
    s_add_u32 s32, s32, s20
    s_mov_b64 exec, s[56:57]
    s_add_u32 m0, s32, 12288
    s_add_u32 s31, s30, 0
    buffer_load_dwordx4 v5, s[4:7], s31 offen lds
    s_add_u32 m0, s32, 13296
    s_add_u32 s31, s30, 30720
    buffer_load_dwordx4 v5, s[4:7], s31 offen lds
    s_add_u32 m0, s32, 14304
    s_add_u32 s31, s30, 61440
    buffer_load_dwordx4 v5, s[4:7], s31 offen lds
    s_add_u32 m0, s32, 15312
    s_add_u32 s31, s30, 92160
    buffer_load_dwordx4 v5, s[4:7], s31 offen lds
    s_add_u32 m0, s32, 16320
    s_add_u32 s31, s30, 122880
    buffer_load_dwordx4 v5, s[4:7], s31 offen lds
    s_cmp_eq_u32 s19, 3
    s_cbranch_scc1 attn_kernel_i5_4
    s_add_u32 m0, s32, 17328
    s_add_u32 s31, s30, 153600
    buffer_load_dwordx4 v5, s[4:7], s31 offen lds
attn_kernel_i5_4:
    s_mov_b64 exec, -1
attn_kernel_ie_3:
    v_lshrrev_b32 v13, 4, v2
    v_and_b32 v16, 15, v2
    v_lshlrev_b32 v11, 1, v13
    v_xor_b32 v11, v11, v16
    v_xor_b32 v12, 8, v11
    v_lshrrev_b32 v16, 4, v2
    v_bfe_u32 v15, v2, 2, 2
    v_lshl_add_u32 v14, v16, 3, v15
    v_lshlrev_b32 v14, 8, v14
    v_and_b32 v17, 3, v2
    v_lshl_add_u32 v14, v17, 3, v14
    s_lshl_b32 s48, s19, 13
    s_add_u32 s48, s48, 70656
    v_add_u32 v14, s48, v14
    v_and_b32 v16, 1, v16
    v_lshl_or_b32 v15, v16, 2, v15
    v_lshlrev_b32 v15, 5, v15
    v_lshlrev_b32 v17, 4, v2
    s_add_u32 s40, s82, 20332544
    s_addc_u32 s41, s83, 0
    s_mov_b32 s42, 7618560
    s_mov_b32 s43, 0x00020000
    s_mov_b32 s23, 0
    s_lshl_b32 s53, s2, 2
    s_add_u32 s53, s53, s19
    s_mov_b32 s52, 0
    s_waitcnt vmcnt(0)
    s_barrier
    s_mov_b32 s20, 23376
    s_mov_b32 s21, 327680
    s_cmp_ge_u32 s19, 2
    s_cbranch_scc1 attn_kernel_iv_5
    s_mul_i32 s30, s19, 163840
    s_add_u32 s30, s30, s21
    s_add_u32 s30, s30, s50
    s_lshl_b32 s32, s19, 12
    s_add_u32 s32, s32, s20
    s_add_u32 m0, s32, 0
    s_add_u32 s31, s30, 0
    buffer_load_dwordx4 v3, s[4:7], s31 offen lds
    s_add_u32 m0, s32, 1024
    s_add_u32 s31, s30, 40960
    buffer_load_dwordx4 v3, s[4:7], s31 offen lds
    s_add_u32 m0, s32, 2048
    s_add_u32 s31, s30, 81920
    buffer_load_dwordx4 v3, s[4:7], s31 offen lds
    s_add_u32 m0, s32, 3072
    s_add_u32 s31, s30, 122880
    buffer_load_dwordx4 v3, s[4:7], s31 offen lds
    s_mul_i32 s30, s19, 163840
    s_add_u32 s30, s30, s21
    s_add_u32 s30, s30, s58
    s_lshl_b32 s32, s19, 11
    s_add_u32 s32, s32, s20
    s_add_u32 m0, s32, 8192
    s_add_u32 s31, s30, 0
    buffer_load_dwordx4 v4, s[4:7], s31 offen lds
    s_add_u32 m0, s32, 9216
    s_add_u32 s31, s30, 81920
    buffer_load_dwordx4 v4, s[4:7], s31 offen lds
    s_branch attn_kernel_ie_6
attn_kernel_iv_5:
    s_sub_u32 s32, s19, 2
    s_mul_i32 s30, s32, 184320
    s_add_u32 s30, s30, s21
    s_add_u32 s30, s30, s51
    s_mul_i32 s32, s32, 6048
    s_add_u32 s32, s32, s20
    s_mov_b64 exec, s[56:57]
    s_add_u32 m0, s32, 12288
    s_add_u32 s31, s30, 0
    buffer_load_dwordx4 v5, s[4:7], s31 offen lds
    s_add_u32 m0, s32, 13296
    s_add_u32 s31, s30, 30720
    buffer_load_dwordx4 v5, s[4:7], s31 offen lds
    s_add_u32 m0, s32, 14304
    s_add_u32 s31, s30, 61440
    buffer_load_dwordx4 v5, s[4:7], s31 offen lds
    s_add_u32 m0, s32, 15312
    s_add_u32 s31, s30, 92160
    buffer_load_dwordx4 v5, s[4:7], s31 offen lds
    s_add_u32 m0, s32, 16320
    s_add_u32 s31, s30, 122880
    buffer_load_dwordx4 v5, s[4:7], s31 offen lds
    s_cmp_eq_u32 s19, 3
    s_cbranch_scc1 attn_kernel_i5_7
    s_add_u32 m0, s32, 17328
    s_add_u32 s31, s30, 153600
    buffer_load_dwordx4 v5, s[4:7], s31 offen lds
attn_kernel_i5_7:
    s_mov_b64 exec, -1
attn_kernel_ie_6:
attn_kernel_smain:
    s_mov_b32 s22, 0
    s_mov_b32 s20, 46752
attn_kernel_sloop:
    s_cmp_lg_u32 s23, 0
    s_cbranch_scc1 attn_kernel_pl_8
    s_cmp_gt_u32 s22, 2
    s_cbranch_scc1 attn_kernel_pl_8
    s_cmp_eq_u32 s22, 1
    s_cbranch_scc1 attn_kernel_c1_10
    s_cmp_eq_u32 s22, 2
    s_cbranch_scc1 attn_kernel_c2_11
    s_cmp_ge_u32 s53, 800
    s_cbranch_scc1 attn_kernel_rd_14
    s_cmp_ge_u32 s53, 160
    s_cbranch_scc1 attn_kernel_rg_13
    s_mul_i32 s30, s53, 3277
    s_lshr_b32 s30, s30, 16
    s_mul_i32 s31, s30, 20
    s_sub_u32 s31, s53, s31
    s_mul_i32 s32, s30, 160
    s_mul_i32 s44, s31, 40960
    s_add_u32 s44, s44, s32
    s_mov_b32 s45, 1280
    s_mul_i32 s46, s53, 5120
    s_add_u32 s46, s46, 0
    s_mov_b32 s47, 5
    s_mov_b32 s36, s68
    s_mov_b32 s37, s69
    s_mov_b32 s38, 819200
    s_branch attn_kernel_re_15
attn_kernel_rg_13:
    s_sub_u32 s49, s53, 160
    s_mul_i32 s30, s49, 1639
    s_lshr_b32 s30, s30, 16
    s_mul_i32 s31, s30, 40
    s_sub_u32 s31, s49, s31
    s_mul_i32 s32, s30, 224
    s_lshr_b32 s49, s31, 1
    s_mul_i32 s44, s49, 110592
    s_add_u32 s44, s44, s32
    s_mov_b32 s45, 3456
    s_mul_i32 s46, s30, 20
    s_add_u32 s46, s46, s49
    s_mul_i32 s46, s46, 14
    s_and_b32 s31, s31, 1
    s_mul_i32 s30, s31, 7
    s_add_u32 s46, s46, s30
    s_lshl_b32 s46, s46, 10
    s_add_u32 s46, s46, 819200
    s_mov_b32 s47, 7
    s_cmp_eq_u32 s31, 0
    s_cselect_b32 s36, s72, s74
    s_cselect_b32 s37, s73, s75
    s_mov_b32 s38, 2211840
    s_branch attn_kernel_re_15
attn_kernel_rd_14:
    s_sub_u32 s49, s53, 800
    s_mul_i32 s30, s49, 1214
    s_lshr_b32 s30, s30, 16
    s_mul_i32 s31, s30, 54
    s_sub_u32 s31, s49, s31
    s_mul_i32 s32, s30, 160
    s_mul_i32 s44, s31, 40960
    s_add_u32 s44, s44, s32
    s_mov_b32 s45, 1280
    s_mul_i32 s46, s49, 5120
    s_add_u32 s46, s46, 5406720
    s_mov_b32 s47, 5
    s_mov_b32 s36, s76
    s_mov_b32 s37, s77
    s_mov_b32 s38, 2211840
attn_kernel_re_15:
    s_mov_b32 s39, 0x00020000
    s_lshl_b32 s49, s47, 1
    v_mul_lo_u32 v16, v13, s45
    v_lshl_add_u32 v9, v11, 4, v16
    v_lshl_add_u32 v10, v12, 4, v16
    v_cmp_gt_u32 s[54:55], s49, v11
    v_cmp_gt_u32 s[26:27], s49, v12
    s_lshl_b32 s31, s45, 2
    s_nop 1
    s_add_u32 m0, s48, 0
    s_mov_b64 exec, s[54:55]
    buffer_load_dwordx4 v9, s[36:39], s44 offen lds
    s_add_u32 s44, s44, s31
    s_add_u32 m0, s48, 1024
    s_mov_b64 exec, s[54:55]
    buffer_load_dwordx4 v9, s[36:39], s44 offen lds
    s_add_u32 s44, s44, s31
    s_add_u32 m0, s48, 2048
    s_mov_b64 exec, s[26:27]
    buffer_load_dwordx4 v10, s[36:39], s44 offen lds
    s_add_u32 s44, s44, s31
    s_add_u32 m0, s48, 3072
    s_mov_b64 exec, s[26:27]
    buffer_load_dwordx4 v10, s[36:39], s44 offen lds
    s_add_u32 s44, s44, s31
    s_add_u32 m0, s48, 4096
    s_mov_b64 exec, s[54:55]
    buffer_load_dwordx4 v9, s[36:39], s44 offen lds
    s_add_u32 s44, s44, s31
    s_add_u32 m0, s48, 5120
    s_mov_b64 exec, s[54:55]
    buffer_load_dwordx4 v9, s[36:39], s44 offen lds
    s_add_u32 s44, s44, s31
    s_add_u32 m0, s48, 6144
    s_mov_b64 exec, s[26:27]
    buffer_load_dwordx4 v10, s[36:39], s44 offen lds
    s_add_u32 s44, s44, s31
    s_add_u32 m0, s48, 7168
    s_mov_b64 exec, s[26:27]
    buffer_load_dwordx4 v10, s[36:39], s44 offen lds
    s_add_u32 s44, s44, s31
    s_mov_b64 exec, -1
    s_add_u32 s53, s53, 1024
    s_waitcnt vmcnt(8)
    s_branch attn_kernel_br_9
attn_kernel_c1_10:
    s_waitcnt vmcnt(5)
    v_xor_b32 v16, 0, v15
    v_add_u32 v16, v16, v14
    ds_read_b64_tr_b16 v[20:21], v16
    ds_read_b64_tr_b16 v[22:23], v16 offset:1024
    v_xor_b32 v16, 32, v15
    v_add_u32 v16, v16, v14
    ds_read_b64_tr_b16 v[24:25], v16
    ds_read_b64_tr_b16 v[26:27], v16 offset:1024
    v_xor_b32 v16, 64, v15
    v_add_u32 v16, v16, v14
    ds_read_b64_tr_b16 v[28:29], v16
    ds_read_b64_tr_b16 v[30:31], v16 offset:1024
    v_xor_b32 v16, 96, v15
    v_add_u32 v16, v16, v14
    ds_read_b64_tr_b16 v[32:33], v16
    ds_read_b64_tr_b16 v[34:35], v16 offset:1024
    v_xor_b32 v16, 128, v15
    v_add_u32 v16, v16, v14
    ds_read_b64_tr_b16 v[36:37], v16
    ds_read_b64_tr_b16 v[38:39], v16 offset:1024
    v_xor_b32 v16, 160, v15
    v_add_u32 v16, v16, v14
    ds_read_b64_tr_b16 v[40:41], v16
    ds_read_b64_tr_b16 v[42:43], v16 offset:1024
    v_xor_b32 v16, 192, v15
    v_add_u32 v16, v16, v14
    ds_read_b64_tr_b16 v[44:45], v16
    ds_read_b64_tr_b16 v[46:47], v16 offset:1024
    s_waitcnt lgkmcnt(0)
    s_add_u32 s30, s46, 0
    buffer_store_dwordx4 v[20:23], v17, s[40:43], s30 offen sc1
    s_add_u32 s30, s46, 1024
    buffer_store_dwordx4 v[24:27], v17, s[40:43], s30 offen sc1
    s_add_u32 s30, s46, 2048
    buffer_store_dwordx4 v[28:31], v17, s[40:43], s30 offen sc1
    s_add_u32 s30, s46, 3072
    buffer_store_dwordx4 v[32:35], v17, s[40:43], s30 offen sc1
    s_add_u32 s30, s46, 4096
    buffer_store_dwordx4 v[36:39], v17, s[40:43], s30 offen sc1
    s_cmp_lt_u32 s47, 7
    s_cbranch_scc1 attn_kernel_r5_16
    s_add_u32 s30, s46, 5120
    buffer_store_dwordx4 v[40:43], v17, s[40:43], s30 offen sc1
    s_add_u32 s30, s46, 6144
    buffer_store_dwordx4 v[44:47], v17, s[40:43], s30 offen sc1
attn_kernel_r5_16:
    s_cmp_ge_u32 s53, 1232
    s_cbranch_scc1 attn_kernel_c1b_12
    s_cmp_ge_u32 s53, 800
    s_cbranch_scc1 attn_kernel_rd_18
    s_cmp_ge_u32 s53, 160
    s_cbranch_scc1 attn_kernel_rg_17
    s_mul_i32 s30, s53, 3277
    s_lshr_b32 s30, s30, 16
    s_mul_i32 s31, s30, 20
    s_sub_u32 s31, s53, s31
    s_mul_i32 s32, s30, 160
    s_mul_i32 s44, s31, 40960
    s_add_u32 s44, s44, s32
    s_mov_b32 s45, 1280
    s_mul_i32 s46, s53, 5120
    s_add_u32 s46, s46, 0
    s_mov_b32 s47, 5
    s_mov_b32 s36, s68
    s_mov_b32 s37, s69
    s_mov_b32 s38, 819200
    s_branch attn_kernel_re_19
attn_kernel_rg_17:
    s_sub_u32 s49, s53, 160
    s_mul_i32 s30, s49, 1639
    s_lshr_b32 s30, s30, 16
    s_mul_i32 s31, s30, 40
    s_sub_u32 s31, s49, s31
    s_mul_i32 s32, s30, 224
    s_lshr_b32 s49, s31, 1
    s_mul_i32 s44, s49, 110592
    s_add_u32 s44, s44, s32
    s_mov_b32 s45, 3456
    s_mul_i32 s46, s30, 20
    s_add_u32 s46, s46, s49
    s_mul_i32 s46, s46, 14
    s_and_b32 s31, s31, 1
    s_mul_i32 s30, s31, 7
    s_add_u32 s46, s46, s30
    s_lshl_b32 s46, s46, 10
    s_add_u32 s46, s46, 819200
    s_mov_b32 s47, 7
    s_cmp_eq_u32 s31, 0
    s_cselect_b32 s36, s72, s74
    s_cselect_b32 s37, s73, s75
    s_mov_b32 s38, 2211840
    s_branch attn_kernel_re_19
attn_kernel_rd_18:
    s_sub_u32 s49, s53, 800
    s_mul_i32 s30, s49, 1214
    s_lshr_b32 s30, s30, 16
    s_mul_i32 s31, s30, 54
    s_sub_u32 s31, s49, s31
    s_mul_i32 s32, s30, 160
    s_mul_i32 s44, s31, 40960
    s_add_u32 s44, s44, s32
    s_mov_b32 s45, 1280
    s_mul_i32 s46, s49, 5120
    s_add_u32 s46, s46, 5406720
    s_mov_b32 s47, 5
    s_mov_b32 s36, s76
    s_mov_b32 s37, s77
    s_mov_b32 s38, 2211840
attn_kernel_re_19:
    s_mov_b32 s39, 0x00020000
    s_lshl_b32 s49, s47, 1
    v_mul_lo_u32 v16, v13, s45
    v_lshl_add_u32 v9, v11, 4, v16
    v_lshl_add_u32 v10, v12, 4, v16
    v_cmp_gt_u32 s[54:55], s49, v11
    v_cmp_gt_u32 s[26:27], s49, v12
    s_lshl_b32 s31, s45, 2
    s_nop 1
    s_add_u32 m0, s48, 0
    s_mov_b64 exec, s[54:55]
    buffer_load_dwordx4 v9, s[36:39], s44 offen lds
    s_add_u32 s44, s44, s31
    s_add_u32 m0, s48, 1024
    s_mov_b64 exec, s[54:55]
    buffer_load_dwordx4 v9, s[36:39], s44 offen lds
    s_add_u32 s44, s44, s31
    s_add_u32 m0, s48, 2048
    s_mov_b64 exec, s[26:27]
    buffer_load_dwordx4 v10, s[36:39], s44 offen lds
    s_add_u32 s44, s44, s31
    s_add_u32 m0, s48, 3072
    s_mov_b64 exec, s[26:27]
    buffer_load_dwordx4 v10, s[36:39], s44 offen lds
    s_add_u32 s44, s44, s31
    s_add_u32 m0, s48, 4096
    s_mov_b64 exec, s[54:55]
    buffer_load_dwordx4 v9, s[36:39], s44 offen lds
    s_add_u32 s44, s44, s31
    s_add_u32 m0, s48, 5120
    s_mov_b64 exec, s[54:55]
    buffer_load_dwordx4 v9, s[36:39], s44 offen lds
    s_add_u32 s44, s44, s31
    s_add_u32 m0, s48, 6144
    s_mov_b64 exec, s[26:27]
    buffer_load_dwordx4 v10, s[36:39], s44 offen lds
    s_add_u32 s44, s44, s31
    s_add_u32 m0, s48, 7168
    s_mov_b64 exec, s[26:27]
    buffer_load_dwordx4 v10, s[36:39], s44 offen lds
    s_add_u32 s44, s44, s31
    s_mov_b64 exec, -1
    s_waitcnt vmcnt(13)
    s_branch attn_kernel_br_9
attn_kernel_c1b_12:
    s_waitcnt vmcnt(5)
    s_branch attn_kernel_br_9
attn_kernel_c2_11:
    s_cmp_ge_u32 s53, 1232
    s_cbranch_scc1 attn_kernel_pl_8
    s_waitcnt vmcnt(5)
    v_xor_b32 v16, 0, v15
    v_add_u32 v16, v16, v14
    ds_read_b64_tr_b16 v[20:21], v16
    ds_read_b64_tr_b16 v[22:23], v16 offset:1024
    v_xor_b32 v16, 32, v15
    v_add_u32 v16, v16, v14
    ds_read_b64_tr_b16 v[24:25], v16
    ds_read_b64_tr_b16 v[26:27], v16 offset:1024
    v_xor_b32 v16, 64, v15
    v_add_u32 v16, v16, v14
    ds_read_b64_tr_b16 v[28:29], v16
    ds_read_b64_tr_b16 v[30:31], v16 offset:1024
    v_xor_b32 v16, 96, v15
    v_add_u32 v16, v16, v14
    ds_read_b64_tr_b16 v[32:33], v16
    ds_read_b64_tr_b16 v[34:35], v16 offset:1024
    v_xor_b32 v16, 128, v15
    v_add_u32 v16, v16, v14
    ds_read_b64_tr_b16 v[36:37], v16
    ds_read_b64_tr_b16 v[38:39], v16 offset:1024
    v_xor_b32 v16, 160, v15
    v_add_u32 v16, v16, v14
    ds_read_b64_tr_b16 v[40:41], v16
    ds_read_b64_tr_b16 v[42:43], v16 offset:1024
    v_xor_b32 v16, 192, v15
    v_add_u32 v16, v16, v14
    ds_read_b64_tr_b16 v[44:45], v16
    ds_read_b64_tr_b16 v[46:47], v16 offset:1024
    s_waitcnt lgkmcnt(0)
    s_add_u32 s30, s46, 0
    buffer_store_dwordx4 v[20:23], v17, s[40:43], s30 offen sc1
    s_add_u32 s30, s46, 1024
    buffer_store_dwordx4 v[24:27], v17, s[40:43], s30 offen sc1
    s_add_u32 s30, s46, 2048
    buffer_store_dwordx4 v[28:31], v17, s[40:43], s30 offen sc1
    s_add_u32 s30, s46, 3072
    buffer_store_dwordx4 v[32:35], v17, s[40:43], s30 offen sc1
    s_add_u32 s30, s46, 4096
    buffer_store_dwordx4 v[36:39], v17, s[40:43], s30 offen sc1
    s_cmp_lt_u32 s47, 7
    s_cbranch_scc1 attn_kernel_r5_20
    s_add_u32 s30, s46, 5120
    buffer_store_dwordx4 v[40:43], v17, s[40:43], s30 offen sc1
    s_add_u32 s30, s46, 6144
    buffer_store_dwordx4 v[44:47], v17, s[40:43], s30 offen sc1
attn_kernel_r5_20:
    s_waitcnt vmcnt(5)
    s_branch attn_kernel_br_9
attn_kernel_pl_8:
    s_waitcnt vmcnt(0)
attn_kernel_br_9:
    s_barrier
    s_cmp_ge_u32 s22, 6
    s_cbranch_scc1 attn_kernel_sk_21
    s_add_u32 s25, s22, 2
    s_mul_i32 s21, s25, 327680
    s_cmp_ge_u32 s19, 2
    s_cbranch_scc1 attn_kernel_iv_22
    s_mul_i32 s30, s19, 163840
    s_add_u32 s30, s30, s21
    s_add_u32 s30, s30, s50
    s_lshl_b32 s32, s19, 12
    s_add_u32 s32, s32, s20
    s_add_u32 m0, s32, 0
    s_add_u32 s31, s30, 0
    buffer_load_dwordx4 v3, s[4:7], s31 offen lds
    s_add_u32 m0, s32, 1024
    s_add_u32 s31, s30, 40960
    buffer_load_dwordx4 v3, s[4:7], s31 offen lds
    s_add_u32 m0, s32, 2048
    s_add_u32 s31, s30, 81920
    buffer_load_dwordx4 v3, s[4:7], s31 offen lds
    s_add_u32 m0, s32, 3072
    s_add_u32 s31, s30, 122880
    buffer_load_dwordx4 v3, s[4:7], s31 offen lds
    s_mul_i32 s30, s19, 163840
    s_add_u32 s30, s30, s21
    s_add_u32 s30, s30, s58
    s_lshl_b32 s32, s19, 11
    s_add_u32 s32, s32, s20
    s_add_u32 m0, s32, 8192
    s_add_u32 s31, s30, 0
    buffer_load_dwordx4 v4, s[4:7], s31 offen lds
    s_add_u32 m0, s32, 9216
    s_add_u32 s31, s30, 81920
    buffer_load_dwordx4 v4, s[4:7], s31 offen lds
    s_branch attn_kernel_ie_23
attn_kernel_iv_22:
    s_sub_u32 s32, s19, 2
    s_mul_i32 s30, s32, 184320
    s_add_u32 s30, s30, s21
    s_add_u32 s30, s30, s51
    s_mul_i32 s32, s32, 6048
    s_add_u32 s32, s32, s20
    s_mov_b64 exec, s[56:57]
    s_add_u32 m0, s32, 12288
    s_add_u32 s31, s30, 0
    buffer_load_dwordx4 v5, s[4:7], s31 offen lds
    s_add_u32 m0, s32, 13296
    s_add_u32 s31, s30, 30720
    buffer_load_dwordx4 v5, s[4:7], s31 offen lds
    s_add_u32 m0, s32, 14304
    s_add_u32 s31, s30, 61440
    buffer_load_dwordx4 v5, s[4:7], s31 offen lds
    s_add_u32 m0, s32, 15312
    s_add_u32 s31, s30, 92160
    buffer_load_dwordx4 v5, s[4:7], s31 offen lds
    s_add_u32 m0, s32, 16320
    s_add_u32 s31, s30, 122880
    buffer_load_dwordx4 v5, s[4:7], s31 offen lds
    s_cmp_eq_u32 s19, 3
    s_cbranch_scc1 attn_kernel_i5_24
    s_add_u32 m0, s32, 17328
    s_add_u32 s31, s30, 153600
    buffer_load_dwordx4 v5, s[4:7], s31 offen lds
attn_kernel_i5_24:
    s_mov_b64 exec, -1
attn_kernel_ie_23:
attn_kernel_sk_21:
    s_add_u32 s20, s20, 23376
    s_cmp_ge_u32 s20, 70128
    s_cselect_b32 s30, 70128, 0
    s_sub_u32 s20, s20, s30
    s_add_u32 s22, s22, 1
    s_cmp_lt_u32 s22, 8
    s_cbranch_scc1 attn_kernel_sloop
    s_cmp_lg_u32 s23, 0
    s_cbranch_scc1 attn_kernel_sfin
    s_barrier
    v_mov_b32 v6, 70384
    ds_read_b32 v7, v6
    s_waitcnt lgkmcnt(0)
    v_readfirstlane_b32 s30, v7
    s_nop 3
    s_cmp_eq_u32 s30, 0
    s_cbranch_scc1 attn_kernel_sfin
    s_mov_b32 s22, 0
    s_mov_b32 s20, 0
attn_kernel_smax:
    s_barrier
    s_mov_b32 s25, s22
    s_mul_i32 s21, s25, 327680
    s_cmp_ge_u32 s19, 2
    s_cbranch_scc1 attn_kernel_iv_25
    s_mul_i32 s30, s19, 163840
    s_add_u32 s30, s30, s21
    s_add_u32 s30, s30, s50
    s_lshl_b32 s32, s19, 12
    s_add_u32 s32, s32, s20
    s_add_u32 m0, s32, 0
    s_add_u32 s31, s30, 0
    buffer_load_dwordx4 v3, s[4:7], s31 offen lds
    s_add_u32 m0, s32, 1024
    s_add_u32 s31, s30, 40960
    buffer_load_dwordx4 v3, s[4:7], s31 offen lds
    s_add_u32 m0, s32, 2048
    s_add_u32 s31, s30, 81920
    buffer_load_dwordx4 v3, s[4:7], s31 offen lds
    s_add_u32 m0, s32, 3072
    s_add_u32 s31, s30, 122880
    buffer_load_dwordx4 v3, s[4:7], s31 offen lds
    s_mul_i32 s30, s19, 163840
    s_add_u32 s30, s30, s21
    s_add_u32 s30, s30, s58
    s_lshl_b32 s32, s19, 11
    s_add_u32 s32, s32, s20
    s_add_u32 m0, s32, 8192
    s_add_u32 s31, s30, 0
    buffer_load_dwordx4 v4, s[4:7], s31 offen lds
    s_add_u32 m0, s32, 9216
    s_add_u32 s31, s30, 81920
    buffer_load_dwordx4 v4, s[4:7], s31 offen lds
    s_branch attn_kernel_ie_26
attn_kernel_iv_25:
    s_sub_u32 s32, s19, 2
    s_mul_i32 s30, s32, 184320
    s_add_u32 s30, s30, s21
    s_add_u32 s30, s30, s51
    s_mul_i32 s32, s32, 6048
    s_add_u32 s32, s32, s20
    s_mov_b64 exec, s[56:57]
    s_add_u32 m0, s32, 12288
    s_add_u32 s31, s30, 0
    buffer_load_dwordx4 v5, s[4:7], s31 offen lds
    s_add_u32 m0, s32, 13296
    s_add_u32 s31, s30, 30720
    buffer_load_dwordx4 v5, s[4:7], s31 offen lds
    s_add_u32 m0, s32, 14304
    s_add_u32 s31, s30, 61440
    buffer_load_dwordx4 v5, s[4:7], s31 offen lds
    s_add_u32 m0, s32, 15312
    s_add_u32 s31, s30, 92160
    buffer_load_dwordx4 v5, s[4:7], s31 offen lds
    s_add_u32 m0, s32, 16320
    s_add_u32 s31, s30, 122880
    buffer_load_dwordx4 v5, s[4:7], s31 offen lds
    s_cmp_eq_u32 s19, 3
    s_cbranch_scc1 attn_kernel_i5_27
    s_add_u32 m0, s32, 17328
    s_add_u32 s31, s30, 153600
    buffer_load_dwordx4 v5, s[4:7], s31 offen lds
attn_kernel_i5_27:
    s_mov_b64 exec, -1
attn_kernel_ie_26:
    s_waitcnt vmcnt(0)
    s_barrier
    s_add_u32 s22, s22, 1
    s_cmp_lt_u32 s22, 8
    s_cbranch_scc1 attn_kernel_smax
    s_barrier
    s_mov_b32 s20, 0
    s_mov_b32 s21, 0
    s_cmp_ge_u32 s19, 2
    s_cbranch_scc1 attn_kernel_iv_28
    s_mul_i32 s30, s19, 163840
    s_add_u32 s30, s30, s21
    s_add_u32 s30, s30, s50
    s_lshl_b32 s32, s19, 12
    s_add_u32 s32, s32, s20
    s_add_u32 m0, s32, 0
    s_add_u32 s31, s30, 0
    buffer_load_dwordx4 v3, s[4:7], s31 offen lds
    s_add_u32 m0, s32, 1024
    s_add_u32 s31, s30, 40960
    buffer_load_dwordx4 v3, s[4:7], s31 offen lds
    s_add_u32 m0, s32, 2048
    s_add_u32 s31, s30, 81920
    buffer_load_dwordx4 v3, s[4:7], s31 offen lds
    s_add_u32 m0, s32, 3072
    s_add_u32 s31, s30, 122880
    buffer_load_dwordx4 v3, s[4:7], s31 offen lds
    s_mul_i32 s30, s19, 163840
    s_add_u32 s30, s30, s21
    s_add_u32 s30, s30, s58
    s_lshl_b32 s32, s19, 11
    s_add_u32 s32, s32, s20
    s_add_u32 m0, s32, 8192
    s_add_u32 s31, s30, 0
    buffer_load_dwordx4 v4, s[4:7], s31 offen lds
    s_add_u32 m0, s32, 9216
    s_add_u32 s31, s30, 81920
    buffer_load_dwordx4 v4, s[4:7], s31 offen lds
    s_branch attn_kernel_ie_29
attn_kernel_iv_28:
    s_sub_u32 s32, s19, 2
    s_mul_i32 s30, s32, 184320
    s_add_u32 s30, s30, s21
    s_add_u32 s30, s30, s51
    s_mul_i32 s32, s32, 6048
    s_add_u32 s32, s32, s20
    s_mov_b64 exec, s[56:57]
    s_add_u32 m0, s32, 12288
    s_add_u32 s31, s30, 0
    buffer_load_dwordx4 v5, s[4:7], s31 offen lds
    s_add_u32 m0, s32, 13296
    s_add_u32 s31, s30, 30720
    buffer_load_dwordx4 v5, s[4:7], s31 offen lds
    s_add_u32 m0, s32, 14304
    s_add_u32 s31, s30, 61440
    buffer_load_dwordx4 v5, s[4:7], s31 offen lds
    s_add_u32 m0, s32, 15312
    s_add_u32 s31, s30, 92160
    buffer_load_dwordx4 v5, s[4:7], s31 offen lds
    s_add_u32 m0, s32, 16320
    s_add_u32 s31, s30, 122880
    buffer_load_dwordx4 v5, s[4:7], s31 offen lds
    s_cmp_eq_u32 s19, 3
    s_cbranch_scc1 attn_kernel_i5_30
    s_add_u32 m0, s32, 17328
    s_add_u32 s31, s30, 153600
    buffer_load_dwordx4 v5, s[4:7], s31 offen lds
attn_kernel_i5_30:
    s_mov_b64 exec, -1
attn_kernel_ie_29:
    s_mov_b32 s20, 23376
    s_mov_b32 s21, 327680
    s_cmp_ge_u32 s19, 2
    s_cbranch_scc1 attn_kernel_iv_31
    s_mul_i32 s30, s19, 163840
    s_add_u32 s30, s30, s21
    s_add_u32 s30, s30, s50
    s_lshl_b32 s32, s19, 12
    s_add_u32 s32, s32, s20
    s_add_u32 m0, s32, 0
    s_add_u32 s31, s30, 0
    buffer_load_dwordx4 v3, s[4:7], s31 offen lds
    s_add_u32 m0, s32, 1024
    s_add_u32 s31, s30, 40960
    buffer_load_dwordx4 v3, s[4:7], s31 offen lds
    s_add_u32 m0, s32, 2048
    s_add_u32 s31, s30, 81920
    buffer_load_dwordx4 v3, s[4:7], s31 offen lds
    s_add_u32 m0, s32, 3072
    s_add_u32 s31, s30, 122880
    buffer_load_dwordx4 v3, s[4:7], s31 offen lds
    s_mul_i32 s30, s19, 163840
    s_add_u32 s30, s30, s21
    s_add_u32 s30, s30, s58
    s_lshl_b32 s32, s19, 11
    s_add_u32 s32, s32, s20
    s_add_u32 m0, s32, 8192
    s_add_u32 s31, s30, 0
    buffer_load_dwordx4 v4, s[4:7], s31 offen lds
    s_add_u32 m0, s32, 9216
    s_add_u32 s31, s30, 81920
    buffer_load_dwordx4 v4, s[4:7], s31 offen lds
    s_branch attn_kernel_ie_32
attn_kernel_iv_31:
    s_sub_u32 s32, s19, 2
    s_mul_i32 s30, s32, 184320
    s_add_u32 s30, s30, s21
    s_add_u32 s30, s30, s51
    s_mul_i32 s32, s32, 6048
    s_add_u32 s32, s32, s20
    s_mov_b64 exec, s[56:57]
    s_add_u32 m0, s32, 12288
    s_add_u32 s31, s30, 0
    buffer_load_dwordx4 v5, s[4:7], s31 offen lds
    s_add_u32 m0, s32, 13296
    s_add_u32 s31, s30, 30720
    buffer_load_dwordx4 v5, s[4:7], s31 offen lds
    s_add_u32 m0, s32, 14304
    s_add_u32 s31, s30, 61440
    buffer_load_dwordx4 v5, s[4:7], s31 offen lds
    s_add_u32 m0, s32, 15312
    s_add_u32 s31, s30, 92160
    buffer_load_dwordx4 v5, s[4:7], s31 offen lds
    s_add_u32 m0, s32, 16320
    s_add_u32 s31, s30, 122880
    buffer_load_dwordx4 v5, s[4:7], s31 offen lds
    s_cmp_eq_u32 s19, 3
    s_cbranch_scc1 attn_kernel_i5_33
    s_add_u32 m0, s32, 17328
    s_add_u32 s31, s30, 153600
    buffer_load_dwordx4 v5, s[4:7], s31 offen lds
attn_kernel_i5_33:
    s_mov_b64 exec, -1
attn_kernel_ie_32:
    s_waitcnt vmcnt(0)
    s_barrier
    s_mov_b32 s23, 1
    s_branch attn_kernel_smain
attn_kernel_sfin:
    s_branch attn_kernel_end
attn_kernel_main_svc:
    s_lshl_b32 s30, s17, 3
    s_add_u32 s30, s30, s18
    s_mul_i32 s30, s30, 40960
    s_mul_i32 s31, s16, 5
    s_add_u32 s31, s31, 1
    s_lshr_b32 s31, s31, 1
    s_and_b32 s32, s16, 1
    s_lshl_b32 s25, s31, 9
    s_add_u32 s24, s30, s25
    s_mul_i32 s26, s32, 4294965768
    s_add_u32 s26, s26, 1024
    s_add_u32 s26, s26, s24
    s_lshl_b32 s27, s32, 3
    v_and_b32 v114, 31, v2
    v_lshrrev_b32 v115, 5, v2
    v_lshlrev_b32 v105, 4, v114
    v_lshl_add_u32 v104, v115, 9, v105
    v_mul_u32_u24 v7, 336, v115
    v_lshl_add_u32 v106, v114, 4, v7
    v_add_u32 v106, 12288, v106
    v_lshrrev_b32 v3, 5, v0
    v_mul_u32_u24 v3, 23376, v3
    v_and_b32 v4, 31, v0
    v_mul_u32_u24 v4, 336, v4
    v_add_u32 v3, v3, v4
    v_add_u32 v3, 12608, v3
    v_mov_b32 v16, 0x3f803f80
    v_mov_b32 v17, 0x3f803f80
    v_mov_b32 v18, 0x3f803f80
    v_mov_b32 v19, 0x3f803f80
    v_cmp_gt_u32 vcc, 96, v0
    s_and_saveexec_b64 s[30:31], vcc
    s_cbranch_execz attn_kernel_no1
    ds_write_b128 v3, v[16:19]
attn_kernel_no1:
    s_mov_b64 exec, -1
    v_mov_b32 v3, 70384
    v_mov_b32 v4, 0
    ds_write_b32 v3, v4
    v_cmp_gt_u32 s[28:29], 32, v2
    v_mov_b32 v14, 0
    v_mov_b32 v15, 0
    s_waitcnt lgkmcnt(0)
    s_mov_b32 s8, s82
    s_mov_b32 s9, s83
    s_mov_b32 s10, 2621440
    s_mov_b32 s11, 0x00020000
    s_add_u32 s12, s82, 7864320
    s_addc_u32 s13, s83, 0
    s_mov_b32 s14, 2621440
    s_mov_b32 s15, 0x00020000
    buffer_load_dwordx4 v[8:11], v104, s[8:11], s24 offen
    buffer_load_dwordx2 v[12:13], v105, s[8:11], s26 offen
    v_add_u32 v105, s27, v105
    v_add_u32 v105, 8192, v105
    v_mov_b32 v82, 0x3f803f80
    v_mov_b32 v83, 0x00003f80
    v_mov_b32 v86, 0x3f803f80
    v_mov_b32 v87, 0x00003f80
    s_mov_b32 s33, 0
    s_mov_b32 s34, 23376
    v_add_u32 v107, s33, v104
    v_add_u32 v108, s33, v105
    v_add_u32 v109, s33, v106
    v_add_u32 v110, s34, v104
    v_add_u32 v111, s34, v105
    v_add_u32 v112, s34, v106
    s_waitcnt vmcnt(0)
    v_cndmask_b32 v12, 0, v12, s[28:29]
    v_cndmask_b32 v13, 0, v13, s[28:29]
    s_barrier
    ds_read_b128 v[72:75], v107 offset:0
    ds_read_b64 v[80:81], v108 offset:0
    s_waitcnt lgkmcnt(0)
    v_mfma_f32_32x32x16_bf16 v[16:31], v[72:75], v[8:11], 0
    v_mfma_f32_32x32x16_bf16 v[16:31], v[80:83], v[12:15], v[16:31]
    ds_read_b128 v[76:79], v107 offset:1024
    ds_read_b64 v[84:85], v108 offset:512
    ds_read_b128 v[88:91], v109 offset:0
    ds_read_b128 v[96:99], v109 offset:672
    s_nop 15
    s_nop 1
    v_max_f32 v113, v16, v17
    v_max3_f32 v113, v18, v19, v113
    v_max3_f32 v113, v20, v21, v113
    v_max3_f32 v113, v22, v23, v113
    v_max3_f32 v113, v24, v25, v113
    v_max3_f32 v113, v26, v27, v113
    v_max3_f32 v113, v28, v29, v113
    v_max3_f32 v113, v30, v31, v113
    v_mov_b32 v3, v113
    s_nop 1
    v_permlane32_swap_b32 v3, v113
    s_nop 1
    v_max_f32 v113, v113, v3
    v_sub_f32 v3, 0, v113
    v_and_b32 v4, 0xffff0000, v3
    v_sub_f32 v3, v3, v4
    v_and_b32 v6, 0xffff0000, v3
    v_sub_f32 v3, v3, v6
    v_lshrrev_b32 v4, 16, v4
    v_or_b32 v4, v4, v6
    v_lshrrev_b32 v3, 16, v3
    v_cndmask_b32 v14, 0, v4, s[28:29]
    v_cndmask_b32 v15, 0, v3, s[28:29]
    s_nop 1
    s_mov_b32 s23, 0
    s_branch attn_kernel_main2
attn_kernel_main:
    s_mov_b32 s33, 0
    s_mov_b32 s34, 23376
    v_add_u32 v107, s33, v104
    v_add_u32 v108, s33, v105
    v_add_u32 v109, s33, v106
    v_add_u32 v110, s34, v104
    v_add_u32 v111, s34, v105
    v_add_u32 v112, s34, v106
    ds_read_b128 v[72:75], v107 offset:0
    ds_read_b64 v[80:81], v108 offset:0
    s_waitcnt lgkmcnt(0)
    ds_read_b128 v[76:79], v107 offset:1024
    ds_read_b64 v[84:85], v108 offset:512
    ds_read_b128 v[88:91], v109 offset:0
    ds_read_b128 v[96:99], v109 offset:672
attn_kernel_main2:
    s_cmp_lg_u32 s18, 0
    s_cbranch_scc1 attn_kernel_npf
    s_cmp_ge_u32 s2, 16
    s_cbranch_scc1 attn_kernel_npf
    s_getpc_b64 s[44:45]
attn_kernel_pc:
    s_add_u32 s44, s44, wo_kernel-attn_kernel_pc
    s_addc_u32 s45, s45, 0
    s_mov_b32 s46, (gu_kernel-wo_kernel)>>7
    v_lshlrev_b32 v121, 7, v2
    v_mov_b32 v122, v2
    v_cmp_gt_u32 vcc, s46, v122
    s_and_saveexec_b64 s[48:49], vcc
    s_cbranch_execz attn_kernel_npf2
    global_load_dword v123, v121, s[44:45]
    s_mov_b64 exec, -1
    v_add_u32 v121, 0x2000, v121
    v_add_u32 v122, 64, v122
attn_kernel_npf2:
    s_mov_b64 exec, -1
attn_kernel_npf:
    s_cmp_lt_u32 s18, 4
    s_cbranch_scc1 attn_kernel_pr_1
    s_setprio 1
attn_kernel_pr_1:
    v_mfma_f32_32x32x16_bf16 v[16:31], v[72:75], v[8:11], 0
    v_mfma_f32_32x32x16_bf16 v[16:31], v[80:83], v[12:15], v[16:31]
    v_mov_b32 v56, 0
    v_mov_b32 v57, 0
    v_mov_b32 v58, 0
    v_mov_b32 v59, 0
    v_mov_b32 v60, 0
    v_mov_b32 v61, 0
    v_mov_b32 v62, 0
    v_mov_b32 v63, 0
    v_mov_b32 v64, 0
    v_mov_b32 v65, 0
    v_mov_b32 v66, 0
    v_mov_b32 v67, 0
    v_mov_b32 v68, 0
    v_mov_b32 v69, 0
    v_mov_b32 v70, 0
    v_mov_b32 v71, 0
    v_mov_b32 v52, 0
    v_mov_b32 v100, 0
    v_mov_b32 v53, 0
    v_mov_b32 v101, 0
    v_mov_b32 v54, 0
    v_mov_b32 v102, 0
    v_mov_b32 v55, 0
    v_mov_b32 v103, 0
    s_mov_b32 s22, 0
    s_mov_b32 s20, 46752
attn_kernel_loop:
    s_waitcnt lgkmcnt(2)
    v_mfma_f32_32x32x16_bf16 v[32:47], v[76:79], v[8:11], 0
    v_exp_f32 v16, v16
    v_exp_f32 v17, v17
    v_exp_f32 v18, v18
    v_exp_f32 v19, v19
    v_mfma_f32_32x32x16_bf16 v[56:71], v[100:103], v[52:55], v[56:71]
    v_exp_f32 v20, v20
    v_exp_f32 v21, v21
    v_exp_f32 v22, v22
    v_exp_f32 v23, v23
    v_cvt_pk_bf16_f32 v48, v16, v17
    v_cvt_pk_bf16_f32 v49, v18, v19
    v_cvt_pk_bf16_f32 v50, v20, v21
    v_cvt_pk_bf16_f32 v51, v22, v23
    v_mfma_f32_32x32x16_bf16 v[32:47], v[84:87], v[12:15], v[32:47]
    ds_read_b128 v[72:75], v107 offset:2048
    ds_read_b64 v[80:81], v108 offset:1024
    v_exp_f32 v24, v24
    v_exp_f32 v25, v25
    v_exp_f32 v26, v26
    v_exp_f32 v27, v27
    s_waitcnt lgkmcnt(2)
    v_mfma_f32_32x32x16_bf16 v[56:71], v[88:91], v[48:51], v[56:71]
    ds_read_b128 v[92:95], v109 offset:1344
    ds_read_b128 v[100:103], v109 offset:2016
    v_exp_f32 v28, v28
    v_exp_f32 v29, v29
    v_exp_f32 v30, v30
    v_exp_f32 v31, v31
    v_cvt_pk_bf16_f32 v52, v24, v25
    v_cvt_pk_bf16_f32 v53, v26, v27
    v_cvt_pk_bf16_f32 v54, v28, v29
    v_cvt_pk_bf16_f32 v55, v30, v31
    s_waitcnt lgkmcnt(2)
    v_mfma_f32_32x32x16_bf16 v[16:31], v[72:75], v[8:11], 0
    v_exp_f32 v32, v32
    v_exp_f32 v33, v33
    v_exp_f32 v34, v34
    v_exp_f32 v35, v35
    v_mfma_f32_32x32x16_bf16 v[56:71], v[96:99], v[52:55], v[56:71]
    v_exp_f32 v36, v36
    v_exp_f32 v37, v37
    v_exp_f32 v38, v38
    v_exp_f32 v39, v39
    v_cvt_pk_bf16_f32 v48, v32, v33
    v_cvt_pk_bf16_f32 v49, v34, v35
    v_cvt_pk_bf16_f32 v50, v36, v37
    v_cvt_pk_bf16_f32 v51, v38, v39
    v_mfma_f32_32x32x16_bf16 v[16:31], v[80:83], v[12:15], v[16:31]
    ds_read_b128 v[76:79], v107 offset:3072
    ds_read_b64 v[84:85], v108 offset:1536
    v_exp_f32 v40, v40
    v_exp_f32 v41, v41
    v_exp_f32 v42, v42
    v_exp_f32 v43, v43
    s_waitcnt lgkmcnt(2)
    v_mfma_f32_32x32x16_bf16 v[56:71], v[92:95], v[48:51], v[56:71]
    ds_read_b128 v[88:91], v109 offset:2688
    ds_read_b128 v[96:99], v109 offset:3360
    v_exp_f32 v44, v44
    v_exp_f32 v45, v45
    v_exp_f32 v46, v46
    v_exp_f32 v47, v47
    v_cvt_pk_bf16_f32 v52, v40, v41
    v_cvt_pk_bf16_f32 v53, v42, v43
    v_cvt_pk_bf16_f32 v54, v44, v45
    v_cvt_pk_bf16_f32 v55, v46, v47
    s_waitcnt lgkmcnt(2)
    v_mfma_f32_32x32x16_bf16 v[32:47], v[76:79], v[8:11], 0
    v_exp_f32 v16, v16
    v_exp_f32 v17, v17
    v_exp_f32 v18, v18
    v_exp_f32 v19, v19
    v_mfma_f32_32x32x16_bf16 v[56:71], v[100:103], v[52:55], v[56:71]
    v_exp_f32 v20, v20
    v_exp_f32 v21, v21
    v_exp_f32 v22, v22
    v_exp_f32 v23, v23
    v_cvt_pk_bf16_f32 v48, v16, v17
    v_cvt_pk_bf16_f32 v49, v18, v19
    v_cvt_pk_bf16_f32 v50, v20, v21
    v_cvt_pk_bf16_f32 v51, v22, v23
    v_mfma_f32_32x32x16_bf16 v[32:47], v[84:87], v[12:15], v[32:47]
    ds_read_b128 v[72:75], v107 offset:4096
    ds_read_b64 v[80:81], v108 offset:2048
    v_exp_f32 v24, v24
    v_exp_f32 v25, v25
    v_exp_f32 v26, v26
    v_exp_f32 v27, v27
    s_waitcnt lgkmcnt(2)
    v_mfma_f32_32x32x16_bf16 v[56:71], v[88:91], v[48:51], v[56:71]
    ds_read_b128 v[92:95], v109 offset:4032
    ds_read_b128 v[100:103], v109 offset:4704
    v_exp_f32 v28, v28
    v_exp_f32 v29, v29
    v_exp_f32 v30, v30
    v_exp_f32 v31, v31
    v_cvt_pk_bf16_f32 v52, v24, v25
    v_cvt_pk_bf16_f32 v53, v26, v27
    v_cvt_pk_bf16_f32 v54, v28, v29
    v_cvt_pk_bf16_f32 v55, v30, v31
    s_waitcnt lgkmcnt(2)
    v_mfma_f32_32x32x16_bf16 v[16:31], v[72:75], v[8:11], 0
    v_exp_f32 v32, v32
    v_exp_f32 v33, v33
    v_exp_f32 v34, v34
    v_exp_f32 v35, v35
    v_mfma_f32_32x32x16_bf16 v[56:71], v[96:99], v[52:55], v[56:71]
    v_exp_f32 v36, v36
    v_exp_f32 v37, v37
    v_exp_f32 v38, v38
    v_exp_f32 v39, v39
    v_cvt_pk_bf16_f32 v48, v32, v33
    v_cvt_pk_bf16_f32 v49, v34, v35
    v_cvt_pk_bf16_f32 v50, v36, v37
    v_cvt_pk_bf16_f32 v51, v38, v39
    v_mfma_f32_32x32x16_bf16 v[16:31], v[80:83], v[12:15], v[16:31]
    ds_read_b128 v[76:79], v107 offset:5120
    ds_read_b64 v[84:85], v108 offset:2560
    v_exp_f32 v40, v40
    v_exp_f32 v41, v41
    v_exp_f32 v42, v42
    v_exp_f32 v43, v43
    s_waitcnt lgkmcnt(2)
    v_mfma_f32_32x32x16_bf16 v[56:71], v[92:95], v[48:51], v[56:71]
    ds_read_b128 v[88:91], v109 offset:5376
    ds_read_b128 v[96:99], v109 offset:6048
    v_exp_f32 v44, v44
    v_exp_f32 v45, v45
    v_exp_f32 v46, v46
    v_exp_f32 v47, v47
    v_cvt_pk_bf16_f32 v52, v40, v41
    v_cvt_pk_bf16_f32 v53, v42, v43
    v_cvt_pk_bf16_f32 v54, v44, v45
    v_cvt_pk_bf16_f32 v55, v46, v47
    s_waitcnt lgkmcnt(2)
    v_mfma_f32_32x32x16_bf16 v[32:47], v[76:79], v[8:11], 0
    v_exp_f32 v16, v16
    v_exp_f32 v17, v17
    v_exp_f32 v18, v18
    v_exp_f32 v19, v19
    v_mfma_f32_32x32x16_bf16 v[56:71], v[100:103], v[52:55], v[56:71]
    v_exp_f32 v20, v20
    v_exp_f32 v21, v21
    v_exp_f32 v22, v22
    v_exp_f32 v23, v23
    v_cvt_pk_bf16_f32 v48, v16, v17
    v_cvt_pk_bf16_f32 v49, v18, v19
    v_cvt_pk_bf16_f32 v50, v20, v21
    v_cvt_pk_bf16_f32 v51, v22, v23
    v_mfma_f32_32x32x16_bf16 v[32:47], v[84:87], v[12:15], v[32:47]
    ds_read_b128 v[72:75], v107 offset:6144
    ds_read_b64 v[80:81], v108 offset:3072
    v_exp_f32 v24, v24
    v_exp_f32 v25, v25
    v_exp_f32 v26, v26
    v_exp_f32 v27, v27
    s_waitcnt lgkmcnt(2)
    v_mfma_f32_32x32x16_bf16 v[56:71], v[88:91], v[48:51], v[56:71]
    ds_read_b128 v[92:95], v109 offset:6720
    ds_read_b128 v[100:103], v109 offset:7392
    v_exp_f32 v28, v28
    v_exp_f32 v29, v29
    v_exp_f32 v30, v30
    v_exp_f32 v31, v31
    v_cvt_pk_bf16_f32 v52, v24, v25
    v_cvt_pk_bf16_f32 v53, v26, v27
    v_cvt_pk_bf16_f32 v54, v28, v29
    v_cvt_pk_bf16_f32 v55, v30, v31
    s_waitcnt lgkmcnt(2)
    v_mfma_f32_32x32x16_bf16 v[16:31], v[72:75], v[8:11], 0
    v_exp_f32 v32, v32
    v_exp_f32 v33, v33
    v_exp_f32 v34, v34
    v_exp_f32 v35, v35
    v_mfma_f32_32x32x16_bf16 v[56:71], v[96:99], v[52:55], v[56:71]
    v_exp_f32 v36, v36
    v_exp_f32 v37, v37
    v_exp_f32 v38, v38
    v_exp_f32 v39, v39
    v_cvt_pk_bf16_f32 v48, v32, v33
    v_cvt_pk_bf16_f32 v49, v34, v35
    v_cvt_pk_bf16_f32 v50, v36, v37
    v_cvt_pk_bf16_f32 v51, v38, v39
    v_mfma_f32_32x32x16_bf16 v[16:31], v[80:83], v[12:15], v[16:31]
    ds_read_b128 v[76:79], v107 offset:7168
    ds_read_b64 v[84:85], v108 offset:3584
    v_exp_f32 v40, v40
    v_exp_f32 v41, v41
    v_exp_f32 v42, v42
    v_exp_f32 v43, v43
    s_waitcnt lgkmcnt(2)
    v_mfma_f32_32x32x16_bf16 v[56:71], v[92:95], v[48:51], v[56:71]
    ds_read_b128 v[88:91], v109 offset:8064
    ds_read_b128 v[96:99], v109 offset:8736
    v_exp_f32 v44, v44
    v_exp_f32 v45, v45
    v_exp_f32 v46, v46
    v_exp_f32 v47, v47
    v_cvt_pk_bf16_f32 v52, v40, v41
    v_cvt_pk_bf16_f32 v53, v42, v43
    v_cvt_pk_bf16_f32 v54, v44, v45
    v_cvt_pk_bf16_f32 v55, v46, v47
    s_barrier
    s_waitcnt lgkmcnt(2)
    v_mfma_f32_32x32x16_bf16 v[32:47], v[76:79], v[8:11], 0
    v_exp_f32 v16, v16
    v_exp_f32 v17, v17
    v_exp_f32 v18, v18
    v_exp_f32 v19, v19
    v_mfma_f32_32x32x16_bf16 v[56:71], v[100:103], v[52:55], v[56:71]
    v_exp_f32 v20, v20
    v_exp_f32 v21, v21
    v_exp_f32 v22, v22
    v_exp_f32 v23, v23
    v_cvt_pk_bf16_f32 v48, v16, v17
    v_cvt_pk_bf16_f32 v49, v18, v19
    v_cvt_pk_bf16_f32 v50, v20, v21
    v_cvt_pk_bf16_f32 v51, v22, v23
    v_mfma_f32_32x32x16_bf16 v[32:47], v[84:87], v[12:15], v[32:47]
    ds_read_b128 v[72:75], v110 offset:0
    ds_read_b64 v[80:81], v111 offset:0
    v_exp_f32 v24, v24
    v_exp_f32 v25, v25
    v_exp_f32 v26, v26
    v_exp_f32 v27, v27
    s_waitcnt lgkmcnt(2)
    v_mfma_f32_32x32x16_bf16 v[56:71], v[88:91], v[48:51], v[56:71]
    ds_read_b128 v[92:95], v109 offset:9408
    ds_read_b128 v[100:103], v109 offset:10080
    v_exp_f32 v28, v28
    v_exp_f32 v29, v29
    v_exp_f32 v30, v30
    v_exp_f32 v31, v31
    v_cvt_pk_bf16_f32 v52, v24, v25
    v_cvt_pk_bf16_f32 v53, v26, v27
    v_cvt_pk_bf16_f32 v54, v28, v29
    v_cvt_pk_bf16_f32 v55, v30, v31
    s_waitcnt lgkmcnt(2)
    v_mfma_f32_32x32x16_bf16 v[16:31], v[72:75], v[8:11], 0
    v_exp_f32 v32, v32
    v_exp_f32 v33, v33
    v_exp_f32 v34, v34
    v_exp_f32 v35, v35
    v_mfma_f32_32x32x16_bf16 v[56:71], v[96:99], v[52:55], v[56:71]
    v_exp_f32 v36, v36
    v_exp_f32 v37, v37
    v_exp_f32 v38, v38
    v_exp_f32 v39, v39
    v_cvt_pk_bf16_f32 v48, v32, v33
    v_cvt_pk_bf16_f32 v49, v34, v35
    v_cvt_pk_bf16_f32 v50, v36, v37
    v_cvt_pk_bf16_f32 v51, v38, v39
    v_mfma_f32_32x32x16_bf16 v[16:31], v[80:83], v[12:15], v[16:31]
    ds_read_b128 v[76:79], v110 offset:1024
    ds_read_b64 v[84:85], v111 offset:512
    v_exp_f32 v40, v40
    v_exp_f32 v41, v41
    v_exp_f32 v42, v42
    v_exp_f32 v43, v43
    s_waitcnt lgkmcnt(2)
    v_mfma_f32_32x32x16_bf16 v[56:71], v[92:95], v[48:51], v[56:71]
    ds_read_b128 v[88:91], v112 offset:0
    ds_read_b128 v[96:99], v112 offset:672
    v_exp_f32 v44, v44
    v_exp_f32 v45, v45
    v_exp_f32 v46, v46
    v_exp_f32 v47, v47
    v_cvt_pk_bf16_f32 v52, v40, v41
    v_cvt_pk_bf16_f32 v53, v42, v43
    v_cvt_pk_bf16_f32 v54, v44, v45
    v_cvt_pk_bf16_f32 v55, v46, v47
    s_add_u32 s22, s22, 1
    s_mov_b32 s30, s33
    s_mov_b32 s33, s34
    s_mov_b32 s34, s20
    s_mov_b32 s20, s30
    v_add_u32 v107, s33, v104
    v_add_u32 v108, s33, v105
    v_add_u32 v109, s33, v106
    v_add_u32 v110, s34, v104
    v_add_u32 v111, s34, v105
    v_add_u32 v112, s34, v106
    s_cmp_lt_u32 s22, 8
    s_cbranch_scc1 attn_kernel_loop
    v_mfma_f32_32x32x16_bf16 v[56:71], v[100:103], v[52:55], v[56:71]
    s_waitcnt lgkmcnt(0)
    s_nop 15
    v_mov_b32 v3, v64
    v_mov_b32 v116, v64
    s_nop 1
    v_permlane32_swap_b32 v3, v116
    v_mov_b32 v117, 0
    v_fma_f32 v117, v56, 0, v117
    v_fma_f32 v117, v57, 0, v117
    v_fma_f32 v117, v58, 0, v117
    v_fma_f32 v117, v59, 0, v117
    v_fma_f32 v117, v60, 0, v117
    v_fma_f32 v117, v61, 0, v117
    v_fma_f32 v117, v62, 0, v117
    v_fma_f32 v117, v63, 0, v117
    v_fma_f32 v117, v64, 0, v117
    v_fma_f32 v117, v65, 0, v117
    v_fma_f32 v117, v66, 0, v117
    v_fma_f32 v117, v67, 0, v117
    s_cmp_lg_u32 s23, 0
    s_cbranch_scc1 attn_kernel_fin
    s_mov_b32 s30, 1568669696
    v_add_f32 v4, v117, v116
    v_cmp_nlt_f32 vcc, v4, s30
    s_cmp_eq_u64 vcc, 0
    s_cbranch_scc1 attn_kernel_noflag
    v_mov_b32 v3, 70384
    v_mov_b32 v4, 1
    ds_write_b32 v3, v4
    s_waitcnt lgkmcnt(0)
attn_kernel_noflag:
    s_barrier
    v_mov_b32 v3, 70384
    ds_read_b32 v4, v3
    s_waitcnt lgkmcnt(0)
    v_readfirstlane_b32 s30, v4
    s_nop 3
    s_cmp_eq_u32 s30, 0
    s_cbranch_scc1 attn_kernel_fin
    v_mov_b32 v14, 0
    v_mov_b32 v15, 0
    v_mov_b32 v113, 0xff7fffff
    s_mov_b32 s22, 0
    s_mov_b32 s33, 0
    v_add_u32 v107, s33, v104
    v_add_u32 v108, s33, v105
    v_add_u32 v109, s33, v106
    v_add_u32 v110, s33, v104
    v_add_u32 v111, s33, v105
    v_add_u32 v112, s33, v106
attn_kernel_maxloop:
    s_barrier
    s_barrier
    ds_read_b128 v[72:75], v107 offset:0
    ds_read_b64 v[80:81], v108 offset:0
    s_waitcnt lgkmcnt(0)
    v_mfma_f32_32x32x16_bf16 v[16:31], v[72:75], v[8:11], 0
    v_mfma_f32_32x32x16_bf16 v[16:31], v[80:83], v[12:15], v[16:31]
    s_nop 15
    s_nop 3
    v_max3_f32 v113, v16, v17, v113
    v_max3_f32 v113, v18, v19, v113
    v_max3_f32 v113, v20, v21, v113
    v_max3_f32 v113, v22, v23, v113
    v_max3_f32 v113, v24, v25, v113
    v_max3_f32 v113, v26, v27, v113
    v_max3_f32 v113, v28, v29, v113
    v_max3_f32 v113, v30, v31, v113
    ds_read_b128 v[72:75], v107 offset:1024
    ds_read_b64 v[80:81], v108 offset:512
    s_waitcnt lgkmcnt(0)
    v_mfma_f32_32x32x16_bf16 v[16:31], v[72:75], v[8:11], 0
    v_mfma_f32_32x32x16_bf16 v[16:31], v[80:83], v[12:15], v[16:31]
    s_nop 15
    s_nop 3
    v_max3_f32 v113, v16, v17, v113
    v_max3_f32 v113, v18, v19, v113
    v_max3_f32 v113, v20, v21, v113
    v_max3_f32 v113, v22, v23, v113
    v_max3_f32 v113, v24, v25, v113
    v_max3_f32 v113, v26, v27, v113
    v_max3_f32 v113, v28, v29, v113
    v_max3_f32 v113, v30, v31, v113
    ds_read_b128 v[72:75], v107 offset:2048
    ds_read_b64 v[80:81], v108 offset:1024
    s_waitcnt lgkmcnt(0)
    v_mfma_f32_32x32x16_bf16 v[16:31], v[72:75], v[8:11], 0
    v_mfma_f32_32x32x16_bf16 v[16:31], v[80:83], v[12:15], v[16:31]
    s_nop 15
    s_nop 3
    v_max3_f32 v113, v16, v17, v113
    v_max3_f32 v113, v18, v19, v113
    v_max3_f32 v113, v20, v21, v113
    v_max3_f32 v113, v22, v23, v113
    v_max3_f32 v113, v24, v25, v113
    v_max3_f32 v113, v26, v27, v113
    v_max3_f32 v113, v28, v29, v113
    v_max3_f32 v113, v30, v31, v113
    ds_read_b128 v[72:75], v107 offset:3072
    ds_read_b64 v[80:81], v108 offset:1536
    s_waitcnt lgkmcnt(0)
    v_mfma_f32_32x32x16_bf16 v[16:31], v[72:75], v[8:11], 0
    v_mfma_f32_32x32x16_bf16 v[16:31], v[80:83], v[12:15], v[16:31]
    s_nop 15
    s_nop 3
    v_max3_f32 v113, v16, v17, v113
    v_max3_f32 v113, v18, v19, v113
    v_max3_f32 v113, v20, v21, v113
    v_max3_f32 v113, v22, v23, v113
    v_max3_f32 v113, v24, v25, v113
    v_max3_f32 v113, v26, v27, v113
    v_max3_f32 v113, v28, v29, v113
    v_max3_f32 v113, v30, v31, v113
    ds_read_b128 v[72:75], v107 offset:4096
    ds_read_b64 v[80:81], v108 offset:2048
    s_waitcnt lgkmcnt(0)
    v_mfma_f32_32x32x16_bf16 v[16:31], v[72:75], v[8:11], 0
    v_mfma_f32_32x32x16_bf16 v[16:31], v[80:83], v[12:15], v[16:31]
    s_nop 15
    s_nop 3
    v_max3_f32 v113, v16, v17, v113
    v_max3_f32 v113, v18, v19, v113
    v_max3_f32 v113, v20, v21, v113
    v_max3_f32 v113, v22, v23, v113
    v_max3_f32 v113, v24, v25, v113
    v_max3_f32 v113, v26, v27, v113
    v_max3_f32 v113, v28, v29, v113
    v_max3_f32 v113, v30, v31, v113
    ds_read_b128 v[72:75], v107 offset:5120
    ds_read_b64 v[80:81], v108 offset:2560
    s_waitcnt lgkmcnt(0)
    v_mfma_f32_32x32x16_bf16 v[16:31], v[72:75], v[8:11], 0
    v_mfma_f32_32x32x16_bf16 v[16:31], v[80:83], v[12:15], v[16:31]
    s_nop 15
    s_nop 3
    v_max3_f32 v113, v16, v17, v113
    v_max3_f32 v113, v18, v19, v113
    v_max3_f32 v113, v20, v21, v113
    v_max3_f32 v113, v22, v23, v113
    v_max3_f32 v113, v24, v25, v113
    v_max3_f32 v113, v26, v27, v113
    v_max3_f32 v113, v28, v29, v113
    v_max3_f32 v113, v30, v31, v113
    ds_read_b128 v[72:75], v107 offset:6144
    ds_read_b64 v[80:81], v108 offset:3072
    s_waitcnt lgkmcnt(0)
    v_mfma_f32_32x32x16_bf16 v[16:31], v[72:75], v[8:11], 0
    v_mfma_f32_32x32x16_bf16 v[16:31], v[80:83], v[12:15], v[16:31]
    s_nop 15
    s_nop 3
    v_max3_f32 v113, v16, v17, v113
    v_max3_f32 v113, v18, v19, v113
    v_max3_f32 v113, v20, v21, v113
    v_max3_f32 v113, v22, v23, v113
    v_max3_f32 v113, v24, v25, v113
    v_max3_f32 v113, v26, v27, v113
    v_max3_f32 v113, v28, v29, v113
    v_max3_f32 v113, v30, v31, v113
    ds_read_b128 v[72:75], v107 offset:7168
    ds_read_b64 v[80:81], v108 offset:3584
    s_waitcnt lgkmcnt(0)
    v_mfma_f32_32x32x16_bf16 v[16:31], v[72:75], v[8:11], 0
    v_mfma_f32_32x32x16_bf16 v[16:31], v[80:83], v[12:15], v[16:31]
    s_nop 15
    s_nop 3
    v_max3_f32 v113, v16, v17, v113
    v_max3_f32 v113, v18, v19, v113
    v_max3_f32 v113, v20, v21, v113
    v_max3_f32 v113, v22, v23, v113
    v_max3_f32 v113, v24, v25, v113
    v_max3_f32 v113, v26, v27, v113
    v_max3_f32 v113, v28, v29, v113
    v_max3_f32 v113, v30, v31, v113
    s_add_u32 s22, s22, 1
    s_cmp_lt_u32 s22, 8
    s_cbranch_scc1 attn_kernel_maxloop
    v_mov_b32 v3, v113
    s_nop 1
    v_permlane32_swap_b32 v3, v113
    s_nop 1
    v_max_f32 v113, v113, v3
    v_sub_f32 v3, 0, v113
    v_and_b32 v4, 0xffff0000, v3
    v_sub_f32 v3, v3, v4
    v_and_b32 v6, 0xffff0000, v3
    v_sub_f32 v3, v3, v6
    v_lshrrev_b32 v4, 16, v4
    v_or_b32 v4, v4, v6
    v_lshrrev_b32 v3, 16, v3
    v_cndmask_b32 v14, 0, v4, s[28:29]
    v_cndmask_b32 v15, 0, v3, s[28:29]
    s_nop 1
    s_mov_b32 s23, 1
    s_barrier
    s_barrier
    s_branch attn_kernel_main
attn_kernel_fin:
    v_rcp_f32 v116, v116
    s_lshl_b32 s30, s17, 2
    s_lshr_b32 s31, s18, 1
    s_add_u32 s30, s30, s31
    s_mul_i32 s30, s30, 81920
    s_and_b32 s31, s18, 1
    s_lshl_b32 s31, s31, 9
    s_add_u32 s30, s30, s31
    v_lshlrev_b32 v120, 4, v114
    v_add_u32 v120, s30, v120
    s_mul_i32 s31, s16, 5
    v_add_u32 v3, s31, v115
    v_add_u32 v3, 0, v3
    v_lshrrev_b32 v4, 1, v3
    v_lshlrev_b32 v4, 10, v4
    v_and_b32 v3, 1, v3
    v_lshl_add_u32 v4, v3, 3, v4
    v_add_u32 v4, v4, v120
    v_mul_f32 v3, v56, v116
    v_mul_f32 v5, v57, v116
    v_mul_f32 v6, v58, v116
    v_mul_f32 v7, v59, v116
    v_cvt_pk_bf16_f32 v118, v3, v5
    v_cvt_pk_bf16_f32 v119, v6, v7
    buffer_store_dwordx2 v[118:119], v4, s[12:15], 0 offen
    s_nop 1
    v_add_u32 v3, s31, v115
    v_add_u32 v3, 2, v3
    v_lshrrev_b32 v4, 1, v3
    v_lshlrev_b32 v4, 10, v4
    v_and_b32 v3, 1, v3
    v_lshl_add_u32 v4, v3, 3, v4
    v_add_u32 v4, v4, v120
    v_mul_f32 v3, v60, v116
    v_mul_f32 v5, v61, v116
    v_mul_f32 v6, v62, v116
    v_mul_f32 v7, v63, v116
    v_cvt_pk_bf16_f32 v118, v3, v5
    v_cvt_pk_bf16_f32 v119, v6, v7
    buffer_store_dwordx2 v[118:119], v4, s[12:15], 0 offen
    s_nop 1
    v_add_u32 v3, s31, v115
    v_add_u32 v3, 4, v3
    v_lshrrev_b32 v4, 1, v3
    v_lshlrev_b32 v4, 10, v4
    v_and_b32 v3, 1, v3
    v_lshl_add_u32 v4, v3, 3, v4
    v_add_u32 v4, v4, v120
    v_mul_f32 v3, v64, v116
    v_mul_f32 v5, v65, v116
    v_mul_f32 v6, v66, v116
    v_mul_f32 v7, v67, v116
    v_cvt_pk_bf16_f32 v118, v3, v5
    v_cvt_pk_bf16_f32 v119, v6, v7
    s_mov_b64 exec, s[28:29]
    buffer_store_dwordx2 v[118:119], v4, s[12:15], 0 offen
    s_nop 1
    s_branch attn_kernel_end
attn_kernel_end:
    s_endpgm
.globl wo_kernel
.p2align 8
.type wo_kernel,@function
wo_kernel:
    s_cmp_ge_u32 s2, 256
    s_cbranch_scc1 wo_kernel_end
    s_load_dwordx16 s[64:79], s[0:1], 0
    s_load_dwordx4 s[80:83], s[0:1], 64
    v_lshrrev_b32 v1, 6, v0
    v_and_b32 v2, 63, v0
    v_readfirstlane_b32 s18, v1
    s_and_b32 s35, s2, 7
    s_lshr_b32 s31, s2, 3
    s_and_b32 s32, s31, 7
    s_lshr_b32 s33, s31, 3
    s_lshr_b32 s34, s35, 1
    s_lshl_b32 s34, s34, 3
    s_add_u32 s16, s34, s32
    s_and_b32 s34, s35, 1
    s_lshl_b32 s34, s34, 2
    s_add_u32 s17, s34, s33
    s_mul_i32 s28, s17, 160
    s_cmp_ge_u32 s18, 4
    s_cbranch_scc0 wo_kernel_main_loader
    s_sub_u32 s18, s18, 4
    v_lshlrev_b32 v3, 4, v2
    s_mul_i32 s50, s18, 2048
    s_mul_i32 s30, s16, 81920
    s_add_u32 s50, s50, s30
    s_mul_i32 s25, s18, 2048
    s_lshl_b32 s27, s18, 10
    s_add_u32 s27, s27, 8192
    s_mul_i32 s51, s17, 102400
    s_lshl_b32 s30, s18, 10
    s_add_u32 s51, s51, s30
    s_add_u32 s51, s51, 0
    s_mul_i32 s30, s32, 1
    s_mul_i32 s31, s33, 3
    s_add_u32 s44, s30, s31
    s_cmp_ge_u32 s44, 10
    s_cselect_b32 s30, 10, 0
    s_sub_u32 s44, s44, s30
    s_cmp_ge_u32 s44, 10
    s_cselect_b32 s30, 10, 0
    s_sub_u32 s44, s44, s30
    s_mov_b32 s46, 0
    s_waitcnt lgkmcnt(0)
    s_add_u32 s4, s82, 7864320
    s_addc_u32 s5, s83, 0
    s_mov_b32 s6, 2621440
    s_mov_b32 s7, 0x00020000
    s_add_u32 s8, s82, 20332544
    s_addc_u32 s9, s83, 0
    s_mov_b32 s10, 7618560
    s_mov_b32 s11, 0x00020000
    s_mul_i32 s47, s44, 8192
    s_add_u32 s47, s47, s50
    s_mul_i32 s48, s44, 10240
    s_add_u32 s48, s48, s51
    s_add_u32 s52, s27, s46
    s_add_u32 s53, s25, s46
    s_add_u32 m0, s52, 0
    s_add_u32 s31, s48, 0
    buffer_load_dwordx4 v3, s[8:11], s31 offen lds
    s_add_u32 m0, s52, 4096
    s_add_u32 s31, s48, 4096
    buffer_load_dwordx4 v3, s[8:11], s31 offen lds
    s_cmp_ge_u32 s18, 2
    s_cbranch_scc1 wo_kernel_sk_1
    s_add_u32 m0, s52, 8192
    s_add_u32 s31, s48, 8192
    buffer_load_dwordx4 v3, s[8:11], s31 offen lds
wo_kernel_sk_1:
    s_add_u32 m0, s53, 0
    s_add_u32 s31, s47, 0
    buffer_load_dwordx4 v3, s[4:7], s31 offen lds
    s_add_u32 m0, s53, 1024
    s_add_u32 s31, s47, 1024
    buffer_load_dwordx4 v3, s[4:7], s31 offen lds
    s_add_u32 s44, s44, 1
    s_cmp_ge_u32 s44, 10
    s_cselect_b32 s30, 10, 0
    s_sub_u32 s44, s44, s30
    s_add_u32 s46, s46, 18432
    s_cmp_ge_u32 s46, 147456
    s_cselect_b32 s30, 147456, 0
    s_sub_u32 s46, s46, s30
    s_mul_i32 s47, s44, 8192
    s_add_u32 s47, s47, s50
    s_mul_i32 s48, s44, 10240
    s_add_u32 s48, s48, s51
    s_add_u32 s52, s27, s46
    s_add_u32 s53, s25, s46
    s_add_u32 m0, s52, 0
    s_add_u32 s31, s48, 0
    buffer_load_dwordx4 v3, s[8:11], s31 offen lds
    s_add_u32 m0, s52, 4096
    s_add_u32 s31, s48, 4096
    buffer_load_dwordx4 v3, s[8:11], s31 offen lds
    s_cmp_ge_u32 s18, 2
    s_cbranch_scc1 wo_kernel_sk_2
    s_add_u32 m0, s52, 8192
    s_add_u32 s31, s48, 8192
    buffer_load_dwordx4 v3, s[8:11], s31 offen lds
wo_kernel_sk_2:
    s_add_u32 m0, s53, 0
    s_add_u32 s31, s47, 0
    buffer_load_dwordx4 v3, s[4:7], s31 offen lds
    s_add_u32 m0, s53, 1024
    s_add_u32 s31, s47, 1024
    buffer_load_dwordx4 v3, s[4:7], s31 offen lds
    s_add_u32 s44, s44, 1
    s_cmp_ge_u32 s44, 10
    s_cselect_b32 s30, 10, 0
    s_sub_u32 s44, s44, s30
    s_add_u32 s46, s46, 18432
    s_cmp_ge_u32 s46, 147456
    s_cselect_b32 s30, 147456, 0
    s_sub_u32 s46, s46, s30
    s_cmp_ge_u32 s18, 2
    s_cbranch_scc1 wo_kernel_w_3
    s_waitcnt vmcnt(5)
    s_branch wo_kernel_w_4
wo_kernel_w_3:
    s_waitcnt vmcnt(4)
wo_kernel_w_4:
    s_barrier
    s_mul_i32 s47, s44, 8192
    s_add_u32 s47, s47, s50
    s_mul_i32 s48, s44, 10240
    s_add_u32 s48, s48, s51
    s_add_u32 s52, s27, s46
    s_add_u32 s53, s25, s46
    s_add_u32 m0, s52, 0
    s_add_u32 s31, s48, 0
    buffer_load_dwordx4 v3, s[8:11], s31 offen lds
    s_add_u32 m0, s52, 4096
    s_add_u32 s31, s48, 4096
    buffer_load_dwordx4 v3, s[8:11], s31 offen lds
    s_cmp_ge_u32 s18, 2
    s_cbranch_scc1 wo_kernel_sk_5
    s_add_u32 m0, s52, 8192
    s_add_u32 s31, s48, 8192
    buffer_load_dwordx4 v3, s[8:11], s31 offen lds
wo_kernel_sk_5:
    s_add_u32 m0, s53, 0
    s_add_u32 s31, s47, 0
    buffer_load_dwordx4 v3, s[4:7], s31 offen lds
    s_add_u32 m0, s53, 1024
    s_add_u32 s31, s47, 1024
    buffer_load_dwordx4 v3, s[4:7], s31 offen lds
    s_add_u32 s44, s44, 1
    s_cmp_ge_u32 s44, 10
    s_cselect_b32 s30, 10, 0
    s_sub_u32 s44, s44, s30
    s_add_u32 s46, s46, 18432
    s_cmp_ge_u32 s46, 147456
    s_cselect_b32 s30, 147456, 0
    s_sub_u32 s46, s46, s30
    s_mul_i32 s47, s44, 8192
    s_add_u32 s47, s47, s50
    s_mul_i32 s48, s44, 10240
    s_add_u32 s48, s48, s51
    s_add_u32 s52, s27, s46
    s_add_u32 s53, s25, s46
    s_add_u32 m0, s52, 0
    s_add_u32 s31, s48, 0
    buffer_load_dwordx4 v3, s[8:11], s31 offen lds
    s_add_u32 m0, s52, 4096
    s_add_u32 s31, s48, 4096
    buffer_load_dwordx4 v3, s[8:11], s31 offen lds
    s_cmp_ge_u32 s18, 2
    s_cbranch_scc1 wo_kernel_sk_6
    s_add_u32 m0, s52, 8192
    s_add_u32 s31, s48, 8192
    buffer_load_dwordx4 v3, s[8:11], s31 offen lds
wo_kernel_sk_6:
    s_add_u32 m0, s53, 0
    s_add_u32 s31, s47, 0
    buffer_load_dwordx4 v3, s[4:7], s31 offen lds
    s_add_u32 m0, s53, 1024
    s_add_u32 s31, s47, 1024
    buffer_load_dwordx4 v3, s[4:7], s31 offen lds
    s_add_u32 s44, s44, 1
    s_cmp_ge_u32 s44, 10
    s_cselect_b32 s30, 10, 0
    s_sub_u32 s44, s44, s30
    s_add_u32 s46, s46, 18432
    s_cmp_ge_u32 s46, 147456
    s_cselect_b32 s30, 147456, 0
    s_sub_u32 s46, s46, s30
    s_cmp_ge_u32 s18, 2
    s_cbranch_scc1 wo_kernel_w_7
    s_waitcnt vmcnt(10)
    s_branch wo_kernel_w_8
wo_kernel_w_7:
    s_waitcnt vmcnt(8)
wo_kernel_w_8:
    s_barrier
    s_mul_i32 s47, s44, 8192
    s_add_u32 s47, s47, s50
    s_mul_i32 s48, s44, 10240
    s_add_u32 s48, s48, s51
    s_add_u32 s52, s27, s46
    s_add_u32 s53, s25, s46
    s_add_u32 m0, s52, 0
    s_add_u32 s31, s48, 0
    buffer_load_dwordx4 v3, s[8:11], s31 offen lds
    s_add_u32 m0, s52, 4096
    s_add_u32 s31, s48, 4096
    buffer_load_dwordx4 v3, s[8:11], s31 offen lds
    s_cmp_ge_u32 s18, 2
    s_cbranch_scc1 wo_kernel_sk_9
    s_add_u32 m0, s52, 8192
    s_add_u32 s31, s48, 8192
    buffer_load_dwordx4 v3, s[8:11], s31 offen lds
wo_kernel_sk_9:
    s_add_u32 m0, s53, 0
    s_add_u32 s31, s47, 0
    buffer_load_dwordx4 v3, s[4:7], s31 offen lds
    s_add_u32 m0, s53, 1024
    s_add_u32 s31, s47, 1024
    buffer_load_dwordx4 v3, s[4:7], s31 offen lds
    s_add_u32 s44, s44, 1
    s_cmp_ge_u32 s44, 10
    s_cselect_b32 s30, 10, 0
    s_sub_u32 s44, s44, s30
    s_add_u32 s46, s46, 18432
    s_cmp_ge_u32 s46, 147456
    s_cselect_b32 s30, 147456, 0
    s_sub_u32 s46, s46, s30
    s_mul_i32 s47, s44, 8192
    s_add_u32 s47, s47, s50
    s_mul_i32 s48, s44, 10240
    s_add_u32 s48, s48, s51
    s_add_u32 s52, s27, s46
    s_add_u32 s53, s25, s46
    s_add_u32 m0, s52, 0
    s_add_u32 s31, s48, 0
    buffer_load_dwordx4 v3, s[8:11], s31 offen lds
    s_add_u32 m0, s52, 4096
    s_add_u32 s31, s48, 4096
    buffer_load_dwordx4 v3, s[8:11], s31 offen lds
    s_cmp_ge_u32 s18, 2
    s_cbranch_scc1 wo_kernel_sk_10
    s_add_u32 m0, s52, 8192
    s_add_u32 s31, s48, 8192
    buffer_load_dwordx4 v3, s[8:11], s31 offen lds
wo_kernel_sk_10:
    s_add_u32 m0, s53, 0
    s_add_u32 s31, s47, 0
    buffer_load_dwordx4 v3, s[4:7], s31 offen lds
    s_add_u32 m0, s53, 1024
    s_add_u32 s31, s47, 1024
    buffer_load_dwordx4 v3, s[4:7], s31 offen lds
    s_add_u32 s44, s44, 1
    s_cmp_ge_u32 s44, 10
    s_cselect_b32 s30, 10, 0
    s_sub_u32 s44, s44, s30
    s_add_u32 s46, s46, 18432
    s_cmp_ge_u32 s46, 147456
    s_cselect_b32 s30, 147456, 0
    s_sub_u32 s46, s46, s30
    s_cmp_ge_u32 s18, 2
    s_cbranch_scc1 wo_kernel_w_11
    s_waitcnt vmcnt(15)
    s_branch wo_kernel_w_12
wo_kernel_w_11:
    s_waitcnt vmcnt(12)
wo_kernel_w_12:
    s_barrier
    s_mul_i32 s47, s44, 8192
    s_add_u32 s47, s47, s50
    s_mul_i32 s48, s44, 10240
    s_add_u32 s48, s48, s51
    s_add_u32 s52, s27, s46
    s_add_u32 s53, s25, s46
    s_add_u32 m0, s52, 0
    s_add_u32 s31, s48, 0
    buffer_load_dwordx4 v3, s[8:11], s31 offen lds
    s_add_u32 m0, s52, 4096
    s_add_u32 s31, s48, 4096
    buffer_load_dwordx4 v3, s[8:11], s31 offen lds
    s_cmp_ge_u32 s18, 2
    s_cbranch_scc1 wo_kernel_sk_13
    s_add_u32 m0, s52, 8192
    s_add_u32 s31, s48, 8192
    buffer_load_dwordx4 v3, s[8:11], s31 offen lds
wo_kernel_sk_13:
    s_add_u32 m0, s53, 0
    s_add_u32 s31, s47, 0
    buffer_load_dwordx4 v3, s[4:7], s31 offen lds
    s_add_u32 m0, s53, 1024
    s_add_u32 s31, s47, 1024
    buffer_load_dwordx4 v3, s[4:7], s31 offen lds
    s_add_u32 s44, s44, 1
    s_cmp_ge_u32 s44, 10
    s_cselect_b32 s30, 10, 0
    s_sub_u32 s44, s44, s30
    s_add_u32 s46, s46, 18432
    s_cmp_ge_u32 s46, 147456
    s_cselect_b32 s30, 147456, 0
    s_sub_u32 s46, s46, s30
    s_mul_i32 s47, s44, 8192
    s_add_u32 s47, s47, s50
    s_mul_i32 s48, s44, 10240
    s_add_u32 s48, s48, s51
    s_add_u32 s52, s27, s46
    s_add_u32 s53, s25, s46
    s_add_u32 m0, s52, 0
    s_add_u32 s31, s48, 0
    buffer_load_dwordx4 v3, s[8:11], s31 offen lds
    s_add_u32 m0, s52, 4096
    s_add_u32 s31, s48, 4096
    buffer_load_dwordx4 v3, s[8:11], s31 offen lds
    s_cmp_ge_u32 s18, 2
    s_cbranch_scc1 wo_kernel_sk_14
    s_add_u32 m0, s52, 8192
    s_add_u32 s31, s48, 8192
    buffer_load_dwordx4 v3, s[8:11], s31 offen lds
wo_kernel_sk_14:
    s_add_u32 m0, s53, 0
    s_add_u32 s31, s47, 0
    buffer_load_dwordx4 v3, s[4:7], s31 offen lds
    s_add_u32 m0, s53, 1024
    s_add_u32 s31, s47, 1024
    buffer_load_dwordx4 v3, s[4:7], s31 offen lds
    s_add_u32 s44, s44, 1
    s_cmp_ge_u32 s44, 10
    s_cselect_b32 s30, 10, 0
    s_sub_u32 s44, s44, s30
    s_add_u32 s46, s46, 18432
    s_cmp_ge_u32 s46, 147456
    s_cselect_b32 s30, 147456, 0
    s_sub_u32 s46, s46, s30
    s_cmp_ge_u32 s18, 2
    s_cbranch_scc1 wo_kernel_w_15
    s_waitcnt vmcnt(20)
    s_branch wo_kernel_w_16
wo_kernel_w_15:
    s_waitcnt vmcnt(16)
wo_kernel_w_16:
    s_barrier
    s_mul_i32 s47, s44, 8192
    s_add_u32 s47, s47, s50
    s_mul_i32 s48, s44, 10240
    s_add_u32 s48, s48, s51
    s_add_u32 s52, s27, s46
    s_add_u32 s53, s25, s46
    s_add_u32 m0, s52, 0
    s_add_u32 s31, s48, 0
    buffer_load_dwordx4 v3, s[8:11], s31 offen lds
    s_add_u32 m0, s52, 4096
    s_add_u32 s31, s48, 4096
    buffer_load_dwordx4 v3, s[8:11], s31 offen lds
    s_cmp_ge_u32 s18, 2
    s_cbranch_scc1 wo_kernel_sk_17
    s_add_u32 m0, s52, 8192
    s_add_u32 s31, s48, 8192
    buffer_load_dwordx4 v3, s[8:11], s31 offen lds
wo_kernel_sk_17:
    s_add_u32 m0, s53, 0
    s_add_u32 s31, s47, 0
    buffer_load_dwordx4 v3, s[4:7], s31 offen lds
    s_add_u32 m0, s53, 1024
    s_add_u32 s31, s47, 1024
    buffer_load_dwordx4 v3, s[4:7], s31 offen lds
    s_add_u32 s44, s44, 1
    s_cmp_ge_u32 s44, 10
    s_cselect_b32 s30, 10, 0
    s_sub_u32 s44, s44, s30
    s_add_u32 s46, s46, 18432
    s_cmp_ge_u32 s46, 147456
    s_cselect_b32 s30, 147456, 0
    s_sub_u32 s46, s46, s30
    s_mul_i32 s47, s44, 8192
    s_add_u32 s47, s47, s50
    s_mul_i32 s48, s44, 10240
    s_add_u32 s48, s48, s51
    s_add_u32 s52, s27, s46
    s_add_u32 s53, s25, s46
    s_add_u32 m0, s52, 0
    s_add_u32 s31, s48, 0
    buffer_load_dwordx4 v3, s[8:11], s31 offen lds
    s_add_u32 m0, s52, 4096
    s_add_u32 s31, s48, 4096
    buffer_load_dwordx4 v3, s[8:11], s31 offen lds
    s_cmp_ge_u32 s18, 2
    s_cbranch_scc1 wo_kernel_sk_18
    s_add_u32 m0, s52, 8192
    s_add_u32 s31, s48, 8192
    buffer_load_dwordx4 v3, s[8:11], s31 offen lds
wo_kernel_sk_18:
    s_add_u32 m0, s53, 0
    s_add_u32 s31, s47, 0
    buffer_load_dwordx4 v3, s[4:7], s31 offen lds
    s_add_u32 m0, s53, 1024
    s_add_u32 s31, s47, 1024
    buffer_load_dwordx4 v3, s[4:7], s31 offen lds
    s_add_u32 s44, s44, 1
    s_cmp_ge_u32 s44, 10
    s_cselect_b32 s30, 10, 0
    s_sub_u32 s44, s44, s30
    s_add_u32 s46, s46, 18432
    s_cmp_ge_u32 s46, 147456
    s_cselect_b32 s30, 147456, 0
    s_sub_u32 s46, s46, s30
    s_lshr_b32 s30, s2, 3
    s_lshl_b32 s30, s30, 2
    s_add_u32 s30, s30, s18
    s_mul_i32 s30, s30, 8960
    s_and_b32 s31, s35, 3
    s_mul_i32 s31, s31, 1146880
    s_add_u32 s30, s30, s31
    s_add_u32 s30, s30, 819200
    v_lshlrev_b32 v4, 7, v2
    buffer_load_dword v5, v4, s[8:11], s30 offen
    s_add_u32 s30, s30, 8192
    s_mov_b64 exec, 0x3f
    buffer_load_dword v5, v4, s[8:11], s30 offen
    s_mov_b64 exec, -1
    s_cmp_ge_u32 s18, 2
    s_cbranch_scc1 wo_kernel_w_19
    s_waitcnt vmcnt(27)
    s_branch wo_kernel_w_20
wo_kernel_w_19:
    s_waitcnt vmcnt(22)
wo_kernel_w_20:
    s_barrier
    s_cmp_ge_u32 s18, 2
    s_cbranch_scc1 wo_kernel_w_21
    s_waitcnt vmcnt(22)
    s_branch wo_kernel_w_22
wo_kernel_w_21:
    s_waitcnt vmcnt(18)
wo_kernel_w_22:
    s_barrier
    s_cmp_ge_u32 s18, 2
    s_cbranch_scc1 wo_kernel_w_23
    s_waitcnt vmcnt(17)
    s_branch wo_kernel_w_24
wo_kernel_w_23:
    s_waitcnt vmcnt(14)
wo_kernel_w_24:
    s_barrier
    s_cmp_ge_u32 s18, 2
    s_cbranch_scc1 wo_kernel_w_25
    s_waitcnt vmcnt(12)
    s_branch wo_kernel_w_26
wo_kernel_w_25:
    s_waitcnt vmcnt(10)
wo_kernel_w_26:
    s_barrier
    s_cmp_ge_u32 s18, 2
    s_cbranch_scc1 wo_kernel_w_27
    s_waitcnt vmcnt(7)
    s_branch wo_kernel_w_28
wo_kernel_w_27:
    s_waitcnt vmcnt(6)
wo_kernel_w_28:
    s_barrier
    s_cmp_ge_u32 s18, 2
    s_cbranch_scc1 wo_kernel_w_29
    s_waitcnt vmcnt(2)
    s_branch wo_kernel_w_30
wo_kernel_w_29:
    s_waitcnt vmcnt(2)
wo_kernel_w_30:
    s_barrier
    s_branch wo_kernel_end
wo_kernel_main_loader:
    s_cmp_lg_u32 s18, 0
    s_cbranch_scc1 wo_kernel_npf
    s_cmp_ge_u32 s2, 16
    s_cbranch_scc1 wo_kernel_npf
    s_getpc_b64 s[44:45]
wo_kernel_pc:
    s_add_u32 s44, s44, gu_kernel-wo_kernel_pc
    s_addc_u32 s45, s45, 0
    s_mov_b32 s46, (down_kernel-gu_kernel)>>7
    v_lshlrev_b32 v80, 7, v2
    v_mov_b32 v81, v2
    v_cmp_gt_u32 vcc, s46, v81
    s_and_saveexec_b64 s[48:49], vcc
    s_cbranch_execz wo_kernel_npf2
    global_load_dword v82, v80, s[44:45]
    s_mov_b64 exec, -1
    v_add_u32 v80, 0x2000, v80
    v_add_u32 v81, 64, v81
wo_kernel_npf2:
    s_mov_b64 exec, -1
wo_kernel_npf:
    v_and_b32 v3, 15, v2
    v_lshrrev_b32 v4, 4, v2
    v_mul_u32_u24 v7, 1024, v4
    v_lshl_add_u32 v7, v3, 4, v7
    s_mul_i32 s30, s18, 256
    v_add_u32 v7, s30, v7
    v_lshlrev_b32 v8, 4, v2
    v_add_u32 v8, 8192, v8
    v_mov_b32 v40, 0
    v_mov_b32 v41, 0
    v_mov_b32 v42, 0
    v_mov_b32 v43, 0
    v_mov_b32 v44, 0
    v_mov_b32 v45, 0
    v_mov_b32 v46, 0
    v_mov_b32 v47, 0
    v_mov_b32 v48, 0
    v_mov_b32 v49, 0
    v_mov_b32 v50, 0
    v_mov_b32 v51, 0
    v_mov_b32 v52, 0
    v_mov_b32 v53, 0
    v_mov_b32 v54, 0
    v_mov_b32 v55, 0
    v_mov_b32 v56, 0
    v_mov_b32 v57, 0
    v_mov_b32 v58, 0
    v_mov_b32 v59, 0
    v_lshrrev_b32 v60, 4, v2
    v_and_b32 v61, 15, v2
    s_mul_i32 s30, s16, 64
    s_mul_i32 s31, s18, 16
    s_add_u32 s30, s30, s31
    v_add_u32 v61, s30, v61
    s_lshr_b32 s29, s30, 6
    v_and_b32 v3, 63, v61
    v_lshlrev_b32 v3, 4, v3
    v_lshrrev_b32 v4, 1, v60
    v_lshl_add_u32 v3, v4, 10, v3
    v_and_b32 v4, 1, v60
    v_lshl_add_u32 v62, v4, 3, v3
    s_waitcnt lgkmcnt(0)
    s_mov_b32 s49, 0
    s_mov_b32 s45, 0
    s_barrier
    v_add_u32 v9, s45, v7
    v_add_u32 v10, s45, v8
    ds_read_b128 v[12:15], v9 offset:0
    ds_read_b128 v[20:23], v10 offset:0
    ds_read_b128 v[24:27], v10 offset:1024
    ds_read_b128 v[28:31], v10 offset:2048
    ds_read_b128 v[32:35], v10 offset:3072
    ds_read_b128 v[36:39], v10 offset:4096
    s_add_u32 s12, s82, 10485760
    s_addc_u32 s13, s83, 0
    s_mov_b32 s14, 2621440
    s_mov_b32 s15, 0x00020000
    s_mov_b32 s36, s64
    s_mov_b32 s37, s65
    s_mov_b32 s38, 2621440
    s_mov_b32 s39, 0x00020000
    s_add_u32 s40, s82, 20201472
    s_addc_u32 s41, s83, 0
    s_mov_b32 s42, 131072
    s_mov_b32 s43, 0x00020000
    v_mul_u32_u24 v3, 1280, v61
    v_lshl_add_u32 v3, v60, 3, v3
    buffer_load_dwordx2 v[64:65], v3, s[36:39], s28 offen offset:0
    buffer_load_dwordx2 v[66:67], v3, s[36:39], s28 offen offset:32
    buffer_load_dwordx2 v[68:69], v3, s[36:39], s28 offen offset:64
    buffer_load_dwordx2 v[70:71], v3, s[36:39], s28 offen offset:96
    buffer_load_dwordx2 v[72:73], v3, s[36:39], s28 offen offset:128
wo_kernel_loop:
    ds_read_b128 v[16:19], v9 offset:4096
    s_waitcnt lgkmcnt(5)
    v_mfma_f32_16x16x32_bf16 v[40:43], v[20:23], v[12:15], v[40:43]
    ds_read_b128 v[20:23], v10 offset:5120
    s_waitcnt lgkmcnt(5)
    v_mfma_f32_16x16x32_bf16 v[44:47], v[24:27], v[12:15], v[44:47]
    ds_read_b128 v[24:27], v10 offset:6144
    s_waitcnt lgkmcnt(5)
    v_mfma_f32_16x16x32_bf16 v[48:51], v[28:31], v[12:15], v[48:51]
    ds_read_b128 v[28:31], v10 offset:7168
    s_waitcnt lgkmcnt(5)
    v_mfma_f32_16x16x32_bf16 v[52:55], v[32:35], v[12:15], v[52:55]
    ds_read_b128 v[32:35], v10 offset:8192
    s_waitcnt lgkmcnt(5)
    v_mfma_f32_16x16x32_bf16 v[56:59], v[36:39], v[12:15], v[56:59]
    ds_read_b128 v[36:39], v10 offset:9216
    s_add_u32 s49, s49, 1
    s_cmp_ge_u32 s49, 10
    s_cbranch_scc1 wo_kernel_tail
    s_add_u32 s45, s45, 18432
    s_cmp_ge_u32 s45, 147456
    s_cselect_b32 s30, 147456, 0
    s_sub_u32 s45, s45, s30
    s_barrier
    v_add_u32 v9, s45, v7
    v_add_u32 v10, s45, v8
    ds_read_b128 v[12:15], v9 offset:0
    s_waitcnt lgkmcnt(5)
    v_mfma_f32_16x16x32_bf16 v[40:43], v[20:23], v[16:19], v[40:43]
    ds_read_b128 v[20:23], v10 offset:0
    s_waitcnt lgkmcnt(5)
    v_mfma_f32_16x16x32_bf16 v[44:47], v[24:27], v[16:19], v[44:47]
    ds_read_b128 v[24:27], v10 offset:1024
    s_waitcnt lgkmcnt(5)
    v_mfma_f32_16x16x32_bf16 v[48:51], v[28:31], v[16:19], v[48:51]
    ds_read_b128 v[28:31], v10 offset:2048
    s_waitcnt lgkmcnt(5)
    v_mfma_f32_16x16x32_bf16 v[52:55], v[32:35], v[16:19], v[52:55]
    ds_read_b128 v[32:35], v10 offset:3072
    s_waitcnt lgkmcnt(5)
    v_mfma_f32_16x16x32_bf16 v[56:59], v[36:39], v[16:19], v[56:59]
    ds_read_b128 v[36:39], v10 offset:4096
    s_branch wo_kernel_loop
wo_kernel_tail:
    s_waitcnt lgkmcnt(0)
    v_mfma_f32_16x16x32_bf16 v[40:43], v[20:23], v[16:19], v[40:43]
    v_mfma_f32_16x16x32_bf16 v[44:47], v[24:27], v[16:19], v[44:47]
    v_mfma_f32_16x16x32_bf16 v[48:51], v[28:31], v[16:19], v[48:51]
    v_mfma_f32_16x16x32_bf16 v[52:55], v[32:35], v[16:19], v[52:55]
    v_mfma_f32_16x16x32_bf16 v[56:59], v[36:39], v[16:19], v[56:59]
    s_waitcnt vmcnt(0)
    v_mov_b32 v6, v62
    s_mul_i32 s30, s17, 10240
    s_mul_i32 s31, s29, 81920
    s_add_u32 s30, s30, s31
    v_mov_b32 v76, 0
    v_mov_b32 v77, 0
    v_lshlrev_b32 v4, 16, v64
    v_and_b32 v5, 0xffff0000, v64
    v_add_f32 v40, v40, v4
    v_add_f32 v41, v41, v5
    v_lshlrev_b32 v4, 16, v65
    v_and_b32 v5, 0xffff0000, v65
    v_add_f32 v42, v42, v4
    v_add_f32 v43, v43, v5
    v_cvt_pk_bf16_f32 v74, v40, v41
    v_cvt_pk_bf16_f32 v75, v42, v43
    s_add_u32 s31, s30, 0
    buffer_store_dwordx2 v[74:75], v6, s[12:15], s31 offen
    v_lshlrev_b32 v4, 16, v74
    v_and_b32 v5, 0xffff0000, v74
    v_add_f32 v76, v76, v4
    v_fmac_f32 v77, v4, v4
    v_add_f32 v76, v76, v5
    v_fmac_f32 v77, v5, v5
    v_lshlrev_b32 v4, 16, v75
    v_and_b32 v5, 0xffff0000, v75
    v_add_f32 v76, v76, v4
    v_fmac_f32 v77, v4, v4
    v_add_f32 v76, v76, v5
    v_fmac_f32 v77, v5, v5
    v_lshlrev_b32 v4, 16, v66
    v_and_b32 v5, 0xffff0000, v66
    v_add_f32 v44, v44, v4
    v_add_f32 v45, v45, v5
    v_lshlrev_b32 v4, 16, v67
    v_and_b32 v5, 0xffff0000, v67
    v_add_f32 v46, v46, v4
    v_add_f32 v47, v47, v5
    v_cvt_pk_bf16_f32 v74, v44, v45
    v_cvt_pk_bf16_f32 v75, v46, v47
    s_add_u32 s31, s30, 2048
    buffer_store_dwordx2 v[74:75], v6, s[12:15], s31 offen
    v_lshlrev_b32 v4, 16, v74
    v_and_b32 v5, 0xffff0000, v74
    v_add_f32 v76, v76, v4
    v_fmac_f32 v77, v4, v4
    v_add_f32 v76, v76, v5
    v_fmac_f32 v77, v5, v5
    v_lshlrev_b32 v4, 16, v75
    v_and_b32 v5, 0xffff0000, v75
    v_add_f32 v76, v76, v4
    v_fmac_f32 v77, v4, v4
    v_add_f32 v76, v76, v5
    v_fmac_f32 v77, v5, v5
    v_lshlrev_b32 v4, 16, v68
    v_and_b32 v5, 0xffff0000, v68
    v_add_f32 v48, v48, v4
    v_add_f32 v49, v49, v5
    v_lshlrev_b32 v4, 16, v69
    v_and_b32 v5, 0xffff0000, v69
    v_add_f32 v50, v50, v4
    v_add_f32 v51, v51, v5
    v_cvt_pk_bf16_f32 v74, v48, v49
    v_cvt_pk_bf16_f32 v75, v50, v51
    s_add_u32 s31, s30, 4096
    buffer_store_dwordx2 v[74:75], v6, s[12:15], s31 offen
    v_lshlrev_b32 v4, 16, v74
    v_and_b32 v5, 0xffff0000, v74
    v_add_f32 v76, v76, v4
    v_fmac_f32 v77, v4, v4
    v_add_f32 v76, v76, v5
    v_fmac_f32 v77, v5, v5
    v_lshlrev_b32 v4, 16, v75
    v_and_b32 v5, 0xffff0000, v75
    v_add_f32 v76, v76, v4
    v_fmac_f32 v77, v4, v4
    v_add_f32 v76, v76, v5
    v_fmac_f32 v77, v5, v5
    v_lshlrev_b32 v4, 16, v70
    v_and_b32 v5, 0xffff0000, v70
    v_add_f32 v52, v52, v4
    v_add_f32 v53, v53, v5
    v_lshlrev_b32 v4, 16, v71
    v_and_b32 v5, 0xffff0000, v71
    v_add_f32 v54, v54, v4
    v_add_f32 v55, v55, v5
    v_cvt_pk_bf16_f32 v74, v52, v53
    v_cvt_pk_bf16_f32 v75, v54, v55
    s_add_u32 s31, s30, 6144
    buffer_store_dwordx2 v[74:75], v6, s[12:15], s31 offen
    v_lshlrev_b32 v4, 16, v74
    v_and_b32 v5, 0xffff0000, v74
    v_add_f32 v76, v76, v4
    v_fmac_f32 v77, v4, v4
    v_add_f32 v76, v76, v5
    v_fmac_f32 v77, v5, v5
    v_lshlrev_b32 v4, 16, v75
    v_and_b32 v5, 0xffff0000, v75
    v_add_f32 v76, v76, v4
    v_fmac_f32 v77, v4, v4
    v_add_f32 v76, v76, v5
    v_fmac_f32 v77, v5, v5
    v_lshlrev_b32 v4, 16, v72
    v_and_b32 v5, 0xffff0000, v72
    v_add_f32 v56, v56, v4
    v_add_f32 v57, v57, v5
    v_lshlrev_b32 v4, 16, v73
    v_and_b32 v5, 0xffff0000, v73
    v_add_f32 v58, v58, v4
    v_add_f32 v59, v59, v5
    v_cvt_pk_bf16_f32 v74, v56, v57
    v_cvt_pk_bf16_f32 v75, v58, v59
    s_add_u32 s31, s30, 8192
    buffer_store_dwordx2 v[74:75], v6, s[12:15], s31 offen
    v_lshlrev_b32 v4, 16, v74
    v_and_b32 v5, 0xffff0000, v74
    v_add_f32 v76, v76, v4
    v_fmac_f32 v77, v4, v4
    v_add_f32 v76, v76, v5
    v_fmac_f32 v77, v5, v5
    v_lshlrev_b32 v4, 16, v75
    v_and_b32 v5, 0xffff0000, v75
    v_add_f32 v76, v76, v4
    v_fmac_f32 v77, v4, v4
    v_add_f32 v76, v76, v5
    v_fmac_f32 v77, v5, v5
    v_mov_b32 v3, v76
    s_nop 1
    v_permlane32_swap_b32 v3, v76
    s_nop 1
    v_add_f32 v76, v76, v3
    v_mov_b32 v3, v76
    s_nop 1
    v_permlane16_swap_b32 v3, v76
    s_nop 1
    v_add_f32 v76, v76, v3
    v_mov_b32 v3, v77
    s_nop 1
    v_permlane32_swap_b32 v3, v77
    s_nop 1
    v_add_f32 v77, v77, v3
    v_mov_b32 v3, v77
    s_nop 1
    v_permlane16_swap_b32 v3, v77
    s_nop 1
    v_add_f32 v77, v77, v3
    v_mov_b32 v78, v76
    v_mov_b32 v79, v77
    v_lshlrev_b32 v3, 6, v61
    s_lshl_b32 s30, s17, 3
    s_mov_b64 exec, 0xffff
    buffer_store_dwordx2 v[78:79], v3, s[40:43], s30 offen
    s_branch wo_kernel_end
wo_kernel_end:
    s_endpgm
.globl gu_kernel
.p2align 8
.type gu_kernel,@function
gu_kernel:
    s_cmp_ge_u32 s2, 256
    s_cbranch_scc1 gu_kernel_end
    s_load_dwordx16 s[64:79], s[0:1], 0
    s_load_dwordx4 s[80:83], s[0:1], 64
    v_lshrrev_b32 v1, 6, v0
    v_and_b32 v2, 63, v0
    v_readfirstlane_b32 s18, v1
    s_and_b32 s35, s2, 7
    s_lshr_b32 s31, s2, 3
    s_and_b32 s32, s31, 7
    s_lshr_b32 s33, s31, 3
    s_lshr_b32 s34, s35, 2
    s_lshl_b32 s34, s34, 3
    s_add_u32 s16, s34, s32
    s_and_b32 s34, s35, 3
    s_lshl_b32 s34, s34, 2
    s_add_u32 s17, s34, s33
    s_mul_i32 s28, s17, 224
    s_cmp_ge_u32 s18, 4
    s_cbranch_scc0 gu_kernel_main_loader
    s_sub_u32 s18, s18, 4
    v_lshlrev_b32 v3, 4, v2
    s_mul_i32 s50, s18, 1024
    s_mul_i32 s30, s16, 163840
    s_add_u32 s50, s50, s30
    s_mul_i32 s25, s18, 2048
    s_lshl_b32 s27, s18, 10
    s_add_u32 s27, s27, 8192
    s_mul_i32 s51, s17, 286720
    s_lshl_b32 s30, s18, 10
    s_add_u32 s51, s51, s30
    s_add_u32 s51, s51, 819200
    s_mul_i32 s30, s32, 2
    s_mul_i32 s31, s33, 5
    s_add_u32 s44, s30, s31
    s_cmp_ge_u32 s44, 20
    s_cselect_b32 s30, 20, 0
    s_sub_u32 s44, s44, s30
    s_cmp_ge_u32 s44, 20
    s_cselect_b32 s30, 20, 0
    s_sub_u32 s44, s44, s30
    s_mov_b32 s46, 0
    s_waitcnt lgkmcnt(0)
    s_add_u32 s4, s82, 10485760
    s_addc_u32 s5, s83, 0
    s_mov_b32 s6, 2621440
    s_mov_b32 s7, 0x00020000
    s_add_u32 s8, s82, 20332544
    s_addc_u32 s9, s83, 0
    s_mov_b32 s10, 7618560
    s_mov_b32 s11, 0x00020000
    s_mul_i32 s47, s44, 4096
    s_add_u32 s47, s47, s50
    s_mul_i32 s48, s44, 14336
    s_add_u32 s48, s48, s51
    s_add_u32 s52, s27, s46
    s_add_u32 s53, s25, s46
    s_add_u32 m0, s52, 0
    s_add_u32 s31, s48, 0
    buffer_load_dwordx4 v3, s[8:11], s31 offen lds
    s_add_u32 m0, s52, 4096
    s_add_u32 s31, s48, 4096
    buffer_load_dwordx4 v3, s[8:11], s31 offen lds
    s_add_u32 m0, s52, 8192
    s_add_u32 s31, s48, 8192
    buffer_load_dwordx4 v3, s[8:11], s31 offen lds
    s_cmp_ge_u32 s18, 2
    s_cbranch_scc1 gu_kernel_sk_1
    s_add_u32 m0, s52, 12288
    s_add_u32 s31, s48, 12288
    buffer_load_dwordx4 v3, s[8:11], s31 offen lds
gu_kernel_sk_1:
    s_add_u32 m0, s53, 0
    s_add_u32 s31, s47, 0
    buffer_load_dwordx4 v3, s[4:7], s31 offen lds
    s_add_u32 m0, s53, 1024
    s_add_u32 s31, s47, 81920
    buffer_load_dwordx4 v3, s[4:7], s31 offen lds
    s_add_u32 s44, s44, 1
    s_cmp_ge_u32 s44, 20
    s_cselect_b32 s30, 20, 0
    s_sub_u32 s44, s44, s30
    s_add_u32 s46, s46, 22528
    s_cmp_ge_u32 s46, 157696
    s_cselect_b32 s30, 157696, 0
    s_sub_u32 s46, s46, s30
    s_mul_i32 s47, s44, 4096
    s_add_u32 s47, s47, s50
    s_mul_i32 s48, s44, 14336
    s_add_u32 s48, s48, s51
    s_add_u32 s52, s27, s46
    s_add_u32 s53, s25, s46
    s_add_u32 m0, s52, 0
    s_add_u32 s31, s48, 0
    buffer_load_dwordx4 v3, s[8:11], s31 offen lds
    s_add_u32 m0, s52, 4096
    s_add_u32 s31, s48, 4096
    buffer_load_dwordx4 v3, s[8:11], s31 offen lds
    s_add_u32 m0, s52, 8192
    s_add_u32 s31, s48, 8192
    buffer_load_dwordx4 v3, s[8:11], s31 offen lds
    s_cmp_ge_u32 s18, 2
    s_cbranch_scc1 gu_kernel_sk_2
    s_add_u32 m0, s52, 12288
    s_add_u32 s31, s48, 12288
    buffer_load_dwordx4 v3, s[8:11], s31 offen lds
gu_kernel_sk_2:
    s_add_u32 m0, s53, 0
    s_add_u32 s31, s47, 0
    buffer_load_dwordx4 v3, s[4:7], s31 offen lds
    s_add_u32 m0, s53, 1024
    s_add_u32 s31, s47, 81920
    buffer_load_dwordx4 v3, s[4:7], s31 offen lds
    s_add_u32 s44, s44, 1
    s_cmp_ge_u32 s44, 20
    s_cselect_b32 s30, 20, 0
    s_sub_u32 s44, s44, s30
    s_add_u32 s46, s46, 22528
    s_cmp_ge_u32 s46, 157696
    s_cselect_b32 s30, 157696, 0
    s_sub_u32 s46, s46, s30
    s_cmp_ge_u32 s18, 2
    s_cbranch_scc1 gu_kernel_w_3
    s_waitcnt vmcnt(6)
    s_branch gu_kernel_w_4
gu_kernel_w_3:
    s_waitcnt vmcnt(5)
gu_kernel_w_4:
    s_barrier
    s_mul_i32 s47, s44, 4096
    s_add_u32 s47, s47, s50
    s_mul_i32 s48, s44, 14336
    s_add_u32 s48, s48, s51
    s_add_u32 s52, s27, s46
    s_add_u32 s53, s25, s46
    s_add_u32 m0, s52, 0
    s_add_u32 s31, s48, 0
    buffer_load_dwordx4 v3, s[8:11], s31 offen lds
    s_add_u32 m0, s52, 4096
    s_add_u32 s31, s48, 4096
    buffer_load_dwordx4 v3, s[8:11], s31 offen lds
    s_add_u32 m0, s52, 8192
    s_add_u32 s31, s48, 8192
    buffer_load_dwordx4 v3, s[8:11], s31 offen lds
    s_cmp_ge_u32 s18, 2
    s_cbranch_scc1 gu_kernel_sk_5
    s_add_u32 m0, s52, 12288
    s_add_u32 s31, s48, 12288
    buffer_load_dwordx4 v3, s[8:11], s31 offen lds
gu_kernel_sk_5:
    s_add_u32 m0, s53, 0
    s_add_u32 s31, s47, 0
    buffer_load_dwordx4 v3, s[4:7], s31 offen lds
    s_add_u32 m0, s53, 1024
    s_add_u32 s31, s47, 81920
    buffer_load_dwordx4 v3, s[4:7], s31 offen lds
    s_add_u32 s44, s44, 1
    s_cmp_ge_u32 s44, 20
    s_cselect_b32 s30, 20, 0
    s_sub_u32 s44, s44, s30
    s_add_u32 s46, s46, 22528
    s_cmp_ge_u32 s46, 157696
    s_cselect_b32 s30, 157696, 0
    s_sub_u32 s46, s46, s30
    s_mul_i32 s47, s44, 4096
    s_add_u32 s47, s47, s50
    s_mul_i32 s48, s44, 14336
    s_add_u32 s48, s48, s51
    s_add_u32 s52, s27, s46
    s_add_u32 s53, s25, s46
    s_add_u32 m0, s52, 0
    s_add_u32 s31, s48, 0
    buffer_load_dwordx4 v3, s[8:11], s31 offen lds
    s_add_u32 m0, s52, 4096
    s_add_u32 s31, s48, 4096
    buffer_load_dwordx4 v3, s[8:11], s31 offen lds
    s_add_u32 m0, s52, 8192
    s_add_u32 s31, s48, 8192
    buffer_load_dwordx4 v3, s[8:11], s31 offen lds
    s_cmp_ge_u32 s18, 2
    s_cbranch_scc1 gu_kernel_sk_6
    s_add_u32 m0, s52, 12288
    s_add_u32 s31, s48, 12288
    buffer_load_dwordx4 v3, s[8:11], s31 offen lds
gu_kernel_sk_6:
    s_add_u32 m0, s53, 0
    s_add_u32 s31, s47, 0
    buffer_load_dwordx4 v3, s[4:7], s31 offen lds
    s_add_u32 m0, s53, 1024
    s_add_u32 s31, s47, 81920
    buffer_load_dwordx4 v3, s[4:7], s31 offen lds
    s_add_u32 s44, s44, 1
    s_cmp_ge_u32 s44, 20
    s_cselect_b32 s30, 20, 0
    s_sub_u32 s44, s44, s30
    s_add_u32 s46, s46, 22528
    s_cmp_ge_u32 s46, 157696
    s_cselect_b32 s30, 157696, 0
    s_sub_u32 s46, s46, s30
    s_cmp_ge_u32 s18, 2
    s_cbranch_scc1 gu_kernel_w_7
    s_waitcnt vmcnt(12)
    s_branch gu_kernel_w_8
gu_kernel_w_7:
    s_waitcnt vmcnt(10)
gu_kernel_w_8:
    s_barrier
    s_mul_i32 s47, s44, 4096
    s_add_u32 s47, s47, s50
    s_mul_i32 s48, s44, 14336
    s_add_u32 s48, s48, s51
    s_add_u32 s52, s27, s46
    s_add_u32 s53, s25, s46
    s_add_u32 m0, s52, 0
    s_add_u32 s31, s48, 0
    buffer_load_dwordx4 v3, s[8:11], s31 offen lds
    s_add_u32 m0, s52, 4096
    s_add_u32 s31, s48, 4096
    buffer_load_dwordx4 v3, s[8:11], s31 offen lds
    s_add_u32 m0, s52, 8192
    s_add_u32 s31, s48, 8192
    buffer_load_dwordx4 v3, s[8:11], s31 offen lds
    s_cmp_ge_u32 s18, 2
    s_cbranch_scc1 gu_kernel_sk_9
    s_add_u32 m0, s52, 12288
    s_add_u32 s31, s48, 12288
    buffer_load_dwordx4 v3, s[8:11], s31 offen lds
gu_kernel_sk_9:
    s_add_u32 m0, s53, 0
    s_add_u32 s31, s47, 0
    buffer_load_dwordx4 v3, s[4:7], s31 offen lds
    s_add_u32 m0, s53, 1024
    s_add_u32 s31, s47, 81920
    buffer_load_dwordx4 v3, s[4:7], s31 offen lds
    s_add_u32 s44, s44, 1
    s_cmp_ge_u32 s44, 20
    s_cselect_b32 s30, 20, 0
    s_sub_u32 s44, s44, s30
    s_add_u32 s46, s46, 22528
    s_cmp_ge_u32 s46, 157696
    s_cselect_b32 s30, 157696, 0
    s_sub_u32 s46, s46, s30
    s_mul_i32 s47, s44, 4096
    s_add_u32 s47, s47, s50
    s_mul_i32 s48, s44, 14336
    s_add_u32 s48, s48, s51
    s_add_u32 s52, s27, s46
    s_add_u32 s53, s25, s46
    s_add_u32 m0, s52, 0
    s_add_u32 s31, s48, 0
    buffer_load_dwordx4 v3, s[8:11], s31 offen lds
    s_add_u32 m0, s52, 4096
    s_add_u32 s31, s48, 4096
    buffer_load_dwordx4 v3, s[8:11], s31 offen lds
    s_add_u32 m0, s52, 8192
    s_add_u32 s31, s48, 8192
    buffer_load_dwordx4 v3, s[8:11], s31 offen lds
    s_cmp_ge_u32 s18, 2
    s_cbranch_scc1 gu_kernel_sk_10
    s_add_u32 m0, s52, 12288
    s_add_u32 s31, s48, 12288
    buffer_load_dwordx4 v3, s[8:11], s31 offen lds
gu_kernel_sk_10:
    s_add_u32 m0, s53, 0
    s_add_u32 s31, s47, 0
    buffer_load_dwordx4 v3, s[4:7], s31 offen lds
    s_add_u32 m0, s53, 1024
    s_add_u32 s31, s47, 81920
    buffer_load_dwordx4 v3, s[4:7], s31 offen lds
    s_add_u32 s44, s44, 1
    s_cmp_ge_u32 s44, 20
    s_cselect_b32 s30, 20, 0
    s_sub_u32 s44, s44, s30
    s_add_u32 s46, s46, 22528
    s_cmp_ge_u32 s46, 157696
    s_cselect_b32 s30, 157696, 0
    s_sub_u32 s46, s46, s30
    s_cmp_ge_u32 s18, 2
    s_cbranch_scc1 gu_kernel_w_11
    s_waitcnt vmcnt(18)
    s_branch gu_kernel_w_12
gu_kernel_w_11:
    s_waitcnt vmcnt(15)
gu_kernel_w_12:
    s_barrier
    s_mul_i32 s47, s44, 4096
    s_add_u32 s47, s47, s50
    s_mul_i32 s48, s44, 14336
    s_add_u32 s48, s48, s51
    s_add_u32 s52, s27, s46
    s_add_u32 s53, s25, s46
    s_add_u32 m0, s52, 0
    s_add_u32 s31, s48, 0
    buffer_load_dwordx4 v3, s[8:11], s31 offen lds
    s_add_u32 m0, s52, 4096
    s_add_u32 s31, s48, 4096
    buffer_load_dwordx4 v3, s[8:11], s31 offen lds
    s_add_u32 m0, s52, 8192
    s_add_u32 s31, s48, 8192
    buffer_load_dwordx4 v3, s[8:11], s31 offen lds
    s_cmp_ge_u32 s18, 2
    s_cbranch_scc1 gu_kernel_sk_13
    s_add_u32 m0, s52, 12288
    s_add_u32 s31, s48, 12288
    buffer_load_dwordx4 v3, s[8:11], s31 offen lds
gu_kernel_sk_13:
    s_add_u32 m0, s53, 0
    s_add_u32 s31, s47, 0
    buffer_load_dwordx4 v3, s[4:7], s31 offen lds
    s_add_u32 m0, s53, 1024
    s_add_u32 s31, s47, 81920
    buffer_load_dwordx4 v3, s[4:7], s31 offen lds
    s_add_u32 s44, s44, 1
    s_cmp_ge_u32 s44, 20
    s_cselect_b32 s30, 20, 0
    s_sub_u32 s44, s44, s30
    s_add_u32 s46, s46, 22528
    s_cmp_ge_u32 s46, 157696
    s_cselect_b32 s30, 157696, 0
    s_sub_u32 s46, s46, s30
    s_mul_i32 s47, s44, 4096
    s_add_u32 s47, s47, s50
    s_mul_i32 s48, s44, 14336
    s_add_u32 s48, s48, s51
    s_add_u32 s52, s27, s46
    s_add_u32 s53, s25, s46
    s_add_u32 m0, s52, 0
    s_add_u32 s31, s48, 0
    buffer_load_dwordx4 v3, s[8:11], s31 offen lds
    s_add_u32 m0, s52, 4096
    s_add_u32 s31, s48, 4096
    buffer_load_dwordx4 v3, s[8:11], s31 offen lds
    s_add_u32 m0, s52, 8192
    s_add_u32 s31, s48, 8192
    buffer_load_dwordx4 v3, s[8:11], s31 offen lds
    s_cmp_ge_u32 s18, 2
    s_cbranch_scc1 gu_kernel_sk_14
    s_add_u32 m0, s52, 12288
    s_add_u32 s31, s48, 12288
    buffer_load_dwordx4 v3, s[8:11], s31 offen lds
gu_kernel_sk_14:
    s_add_u32 m0, s53, 0
    s_add_u32 s31, s47, 0
    buffer_load_dwordx4 v3, s[4:7], s31 offen lds
    s_add_u32 m0, s53, 1024
    s_add_u32 s31, s47, 81920
    buffer_load_dwordx4 v3, s[4:7], s31 offen lds
    s_add_u32 s44, s44, 1
    s_cmp_ge_u32 s44, 20
    s_cselect_b32 s30, 20, 0
    s_sub_u32 s44, s44, s30
    s_add_u32 s46, s46, 22528
    s_cmp_ge_u32 s46, 157696
    s_cselect_b32 s30, 157696, 0
    s_sub_u32 s46, s46, s30
    s_mov_b32 s49, 0
gu_kernel_ll_15:
    s_cmp_ge_u32 s18, 2
    s_cbranch_scc1 gu_kernel_w_16
    s_waitcnt vmcnt(24)
    s_branch gu_kernel_w_17
gu_kernel_w_16:
    s_waitcnt vmcnt(20)
gu_kernel_w_17:
    s_barrier
    s_mul_i32 s47, s44, 4096
    s_add_u32 s47, s47, s50
    s_mul_i32 s48, s44, 14336
    s_add_u32 s48, s48, s51
    s_add_u32 s52, s27, s46
    s_add_u32 s53, s25, s46
    s_add_u32 m0, s52, 0
    s_add_u32 s31, s48, 0
    buffer_load_dwordx4 v3, s[8:11], s31 offen lds
    s_add_u32 m0, s52, 4096
    s_add_u32 s31, s48, 4096
    buffer_load_dwordx4 v3, s[8:11], s31 offen lds
    s_add_u32 m0, s52, 8192
    s_add_u32 s31, s48, 8192
    buffer_load_dwordx4 v3, s[8:11], s31 offen lds
    s_cmp_ge_u32 s18, 2
    s_cbranch_scc1 gu_kernel_sk_18
    s_add_u32 m0, s52, 12288
    s_add_u32 s31, s48, 12288
    buffer_load_dwordx4 v3, s[8:11], s31 offen lds
gu_kernel_sk_18:
    s_add_u32 m0, s53, 0
    s_add_u32 s31, s47, 0
    buffer_load_dwordx4 v3, s[4:7], s31 offen lds
    s_add_u32 m0, s53, 1024
    s_add_u32 s31, s47, 81920
    buffer_load_dwordx4 v3, s[4:7], s31 offen lds
    s_add_u32 s44, s44, 1
    s_cmp_ge_u32 s44, 20
    s_cselect_b32 s30, 20, 0
    s_sub_u32 s44, s44, s30
    s_add_u32 s46, s46, 22528
    s_cmp_ge_u32 s46, 157696
    s_cselect_b32 s30, 157696, 0
    s_sub_u32 s46, s46, s30
    s_add_u32 s49, s49, 1
    s_cmp_lt_u32 s49, 12
    s_cbranch_scc1 gu_kernel_ll_15
    s_lshr_b32 s30, s2, 3
    s_lshl_b32 s30, s30, 2
    s_add_u32 s30, s30, s18
    s_mul_i32 s30, s30, 8960
    s_and_b32 s31, s35, 1
    s_mul_i32 s31, s31, 1105920
    s_add_u32 s30, s30, s31
    s_add_u32 s30, s30, 5406720
    v_lshlrev_b32 v4, 7, v2
    buffer_load_dword v5, v4, s[8:11], s30 offen
    s_add_u32 s30, s30, 8192
    s_mov_b64 exec, 0x3f
    buffer_load_dword v5, v4, s[8:11], s30 offen
    s_mov_b64 exec, -1
    s_cmp_ge_u32 s18, 2
    s_cbranch_scc1 gu_kernel_w_19
    s_waitcnt vmcnt(26)
    s_branch gu_kernel_w_20
gu_kernel_w_19:
    s_waitcnt vmcnt(22)
gu_kernel_w_20:
    s_barrier
    s_cmp_ge_u32 s18, 2
    s_cbranch_scc1 gu_kernel_w_21
    s_waitcnt vmcnt(20)
    s_branch gu_kernel_w_22
gu_kernel_w_21:
    s_waitcnt vmcnt(17)
gu_kernel_w_22:
    s_barrier
    s_cmp_ge_u32 s18, 2
    s_cbranch_scc1 gu_kernel_w_23
    s_waitcnt vmcnt(14)
    s_branch gu_kernel_w_24
gu_kernel_w_23:
    s_waitcnt vmcnt(12)
gu_kernel_w_24:
    s_barrier
    s_cmp_ge_u32 s18, 2
    s_cbranch_scc1 gu_kernel_w_25
    s_waitcnt vmcnt(8)
    s_branch gu_kernel_w_26
gu_kernel_w_25:
    s_waitcnt vmcnt(7)
gu_kernel_w_26:
    s_barrier
    s_cmp_ge_u32 s18, 2
    s_cbranch_scc1 gu_kernel_w_27
    s_waitcnt vmcnt(2)
    s_branch gu_kernel_w_28
gu_kernel_w_27:
    s_waitcnt vmcnt(2)
gu_kernel_w_28:
    s_barrier
    s_branch gu_kernel_end
gu_kernel_main_loader:
    s_cmp_lg_u32 s18, 0
    s_cbranch_scc1 gu_kernel_npf
    s_cmp_ge_u32 s2, 16
    s_cbranch_scc1 gu_kernel_npf
    s_getpc_b64 s[44:45]
gu_kernel_pc:
    s_add_u32 s44, s44, down_kernel-gu_kernel_pc
    s_addc_u32 s45, s45, 0
    s_mov_b32 s46, (code_end-down_kernel)>>7
    v_lshlrev_b32 v252, 7, v2
    v_mov_b32 v253, v2
    v_cmp_gt_u32 vcc, s46, v253
    s_and_saveexec_b64 s[48:49], vcc
    s_cbranch_execz gu_kernel_npf2
    global_load_dword v254, v252, s[44:45]
    s_mov_b64 exec, -1
    v_add_u32 v252, 0x2000, v252
    v_add_u32 v253, 64, v253
gu_kernel_npf2:
    s_mov_b64 exec, -1
gu_kernel_npf:
    v_and_b32 v3, 15, v2
    v_lshrrev_b32 v4, 4, v2
    v_mul_u32_u24 v7, 2048, v4
    v_lshl_add_u32 v7, v3, 4, v7
    s_mul_i32 s30, s18, 512
    v_add_u32 v7, s30, v7
    v_lshlrev_b32 v8, 4, v2
    v_add_u32 v8, 8192, v8
    v_mov_b32 v44, 0
    v_mov_b32 v45, 0
    v_mov_b32 v46, 0
    v_mov_b32 v47, 0
    v_mov_b32 v48, 0
    v_mov_b32 v49, 0
    v_mov_b32 v50, 0
    v_mov_b32 v51, 0
    v_mov_b32 v52, 0
    v_mov_b32 v53, 0
    v_mov_b32 v54, 0
    v_mov_b32 v55, 0
    v_mov_b32 v56, 0
    v_mov_b32 v57, 0
    v_mov_b32 v58, 0
    v_mov_b32 v59, 0
    v_mov_b32 v60, 0
    v_mov_b32 v61, 0
    v_mov_b32 v62, 0
    v_mov_b32 v63, 0
    v_mov_b32 v64, 0
    v_mov_b32 v65, 0
    v_mov_b32 v66, 0
    v_mov_b32 v67, 0
    v_mov_b32 v68, 0
    v_mov_b32 v69, 0
    v_mov_b32 v70, 0
    v_mov_b32 v71, 0
    v_mov_b32 v72, 0
    v_mov_b32 v73, 0
    v_mov_b32 v74, 0
    v_mov_b32 v75, 0
    v_mov_b32 v76, 0
    v_mov_b32 v77, 0
    v_mov_b32 v78, 0
    v_mov_b32 v79, 0
    v_mov_b32 v80, 0
    v_mov_b32 v81, 0
    v_mov_b32 v82, 0
    v_mov_b32 v83, 0
    v_mov_b32 v84, 0
    v_mov_b32 v85, 0
    v_mov_b32 v86, 0
    v_mov_b32 v87, 0
    v_mov_b32 v88, 0
    v_mov_b32 v89, 0
    v_mov_b32 v90, 0
    v_mov_b32 v91, 0
    v_mov_b32 v92, 0
    v_mov_b32 v93, 0
    v_mov_b32 v94, 0
    v_mov_b32 v95, 0
    v_mov_b32 v96, 0
    v_mov_b32 v97, 0
    v_mov_b32 v98, 0
    v_mov_b32 v99, 0
    v_mov_b32 v100, 0
    v_mov_b32 v101, 0
    v_mov_b32 v102, 0
    v_mov_b32 v103, 0
    v_mov_b32 v104, 0
    v_mov_b32 v105, 0
    v_mov_b32 v106, 0
    v_mov_b32 v107, 0
    v_mov_b32 v108, 0
    v_mov_b32 v109, 0
    v_mov_b32 v110, 0
    v_mov_b32 v111, 0
    v_mov_b32 v112, 0
    v_mov_b32 v113, 0
    v_mov_b32 v114, 0
    v_mov_b32 v115, 0
    v_mov_b32 v116, 0
    v_mov_b32 v117, 0
    v_mov_b32 v118, 0
    v_mov_b32 v119, 0
    v_mov_b32 v120, 0
    v_mov_b32 v121, 0
    v_mov_b32 v122, 0
    v_mov_b32 v123, 0
    v_mov_b32 v124, 0
    v_mov_b32 v125, 0
    v_mov_b32 v126, 0
    v_mov_b32 v127, 0
    v_mov_b32 v128, 0
    v_mov_b32 v129, 0
    v_mov_b32 v130, 0
    v_mov_b32 v131, 0
    v_mov_b32 v132, 0
    v_mov_b32 v133, 0
    v_mov_b32 v134, 0
    v_mov_b32 v135, 0
    v_mov_b32 v136, 0
    v_mov_b32 v137, 0
    v_mov_b32 v138, 0
    v_mov_b32 v139, 0
    v_mov_b32 v140, 0
    v_mov_b32 v141, 0
    v_mov_b32 v142, 0
    v_mov_b32 v143, 0
    v_mov_b32 v144, 0
    v_mov_b32 v145, 0
    v_mov_b32 v146, 0
    v_mov_b32 v147, 0
    v_mov_b32 v148, 0
    v_mov_b32 v149, 0
    v_mov_b32 v150, 0
    v_mov_b32 v151, 0
    v_mov_b32 v152, 0
    v_mov_b32 v153, 0
    v_mov_b32 v154, 0
    v_mov_b32 v155, 0
    v_lshrrev_b32 v156, 4, v2
    v_and_b32 v157, 15, v2
    s_mul_i32 s30, s16, 128
    s_mul_i32 s31, s18, 32
    s_add_u32 s30, s30, s31
    v_add_u32 v157, s30, v157
    s_lshr_b32 s29, s30, 6
    v_and_b32 v3, 63, v157
    v_lshlrev_b32 v3, 4, v3
    v_lshrrev_b32 v4, 1, v156
    v_lshl_add_u32 v3, v4, 10, v3
    v_and_b32 v4, 1, v156
    v_lshl_add_u32 v158, v4, 3, v3
    s_waitcnt lgkmcnt(0)
    s_mov_b32 s49, 0
    s_mov_b32 s45, 0
    s_barrier
    v_add_u32 v9, s45, v7
    v_add_u32 v10, s45, v8
    ds_read_b128 v[12:15], v9 offset:0
    ds_read_b128 v[16:19], v9 offset:256
    ds_read_b128 v[28:31], v10 offset:0
    ds_read_b128 v[32:35], v10 offset:1024
    ds_read_b128 v[36:39], v10 offset:2048
    ds_read_b128 v[40:43], v10 offset:3072
    s_add_u32 s12, s82, 13107200
    s_addc_u32 s13, s83, 0
    s_mov_b32 s14, 7077888
    s_mov_b32 s15, 0x00020000
    s_add_u32 s36, s82, 20185088
    s_addc_u32 s37, s83, 0
    s_mov_b32 s38, 13824
    s_mov_b32 s39, 0x00020000
    s_add_u32 s40, s82, 20201472
    s_addc_u32 s41, s83, 0
    s_mov_b32 s42, 131072
    s_mov_b32 s43, 0x00020000
    v_lshlrev_b32 v3, 4, v156
    s_mul_i32 s30, s17, 448
    s_add_u32 s31, s30, 0
    buffer_load_dwordx4 v[160:163], v3, s[36:39], s31 offen
    s_add_u32 s31, s30, 64
    buffer_load_dwordx4 v[164:167], v3, s[36:39], s31 offen
    s_add_u32 s31, s30, 128
    buffer_load_dwordx4 v[168:171], v3, s[36:39], s31 offen
    s_add_u32 s31, s30, 192
    buffer_load_dwordx4 v[172:175], v3, s[36:39], s31 offen
    s_add_u32 s31, s30, 256
    buffer_load_dwordx4 v[176:179], v3, s[36:39], s31 offen
    s_add_u32 s31, s30, 320
    buffer_load_dwordx4 v[180:183], v3, s[36:39], s31 offen
    s_add_u32 s31, s30, 384
    buffer_load_dwordx4 v[184:187], v3, s[36:39], s31 offen
    s_add_u32 s31, s30, 6912
    buffer_load_dwordx4 v[188:191], v3, s[36:39], s31 offen
    s_add_u32 s31, s30, 6976
    buffer_load_dwordx4 v[192:195], v3, s[36:39], s31 offen
    s_add_u32 s31, s30, 7040
    buffer_load_dwordx4 v[196:199], v3, s[36:39], s31 offen
    s_add_u32 s31, s30, 7104
    buffer_load_dwordx4 v[200:203], v3, s[36:39], s31 offen
    s_add_u32 s31, s30, 7168
    buffer_load_dwordx4 v[204:207], v3, s[36:39], s31 offen
    s_add_u32 s31, s30, 7232
    buffer_load_dwordx4 v[208:211], v3, s[36:39], s31 offen
    s_add_u32 s31, s30, 7296
    buffer_load_dwordx4 v[212:215], v3, s[36:39], s31 offen
    v_lshlrev_b32 v4, 6, v157
    v_lshl_add_u32 v4, v156, 4, v4
    buffer_load_dwordx4 v[216:219], v4, s[40:43], 0 offen offset:0
    buffer_load_dwordx4 v[220:223], v4, s[40:43], 0 offen offset:1024
gu_kernel_loop:
    s_waitcnt lgkmcnt(3)
    v_mfma_f32_16x16x32_bf16 v[44:47], v[28:31], v[12:15], v[44:47]
    v_mfma_f32_16x16x32_bf16 v[48:51], v[28:31], v[16:19], v[48:51]
    ds_read_b128 v[28:31], v10 offset:4096
    s_waitcnt lgkmcnt(3)
    v_mfma_f32_16x16x32_bf16 v[52:55], v[32:35], v[12:15], v[52:55]
    v_mfma_f32_16x16x32_bf16 v[56:59], v[32:35], v[16:19], v[56:59]
    ds_read_b128 v[32:35], v10 offset:5120
    s_waitcnt lgkmcnt(3)
    v_mfma_f32_16x16x32_bf16 v[60:63], v[36:39], v[12:15], v[60:63]
    v_mfma_f32_16x16x32_bf16 v[64:67], v[36:39], v[16:19], v[64:67]
    ds_read_b128 v[36:39], v10 offset:6144
    s_waitcnt lgkmcnt(3)
    v_mfma_f32_16x16x32_bf16 v[68:71], v[40:43], v[12:15], v[68:71]
    v_mfma_f32_16x16x32_bf16 v[72:75], v[40:43], v[16:19], v[72:75]
    ds_read_b128 v[40:43], v10 offset:7168
    s_waitcnt lgkmcnt(3)
    v_mfma_f32_16x16x32_bf16 v[76:79], v[28:31], v[12:15], v[76:79]
    v_mfma_f32_16x16x32_bf16 v[80:83], v[28:31], v[16:19], v[80:83]
    ds_read_b128 v[28:31], v10 offset:8192
    s_waitcnt lgkmcnt(3)
    v_mfma_f32_16x16x32_bf16 v[84:87], v[32:35], v[12:15], v[84:87]
    v_mfma_f32_16x16x32_bf16 v[88:91], v[32:35], v[16:19], v[88:91]
    ds_read_b128 v[32:35], v10 offset:9216
    s_waitcnt lgkmcnt(3)
    v_mfma_f32_16x16x32_bf16 v[92:95], v[36:39], v[12:15], v[92:95]
    v_mfma_f32_16x16x32_bf16 v[96:99], v[36:39], v[16:19], v[96:99]
    ds_read_b128 v[36:39], v10 offset:10240
    s_waitcnt lgkmcnt(3)
    v_mfma_f32_16x16x32_bf16 v[100:103], v[40:43], v[12:15], v[100:103]
    v_mfma_f32_16x16x32_bf16 v[104:107], v[40:43], v[16:19], v[104:107]
    ds_read_b128 v[40:43], v10 offset:11264
    s_waitcnt lgkmcnt(3)
    v_mfma_f32_16x16x32_bf16 v[108:111], v[28:31], v[12:15], v[108:111]
    v_mfma_f32_16x16x32_bf16 v[112:115], v[28:31], v[16:19], v[112:115]
    ds_read_b128 v[28:31], v10 offset:12288
    s_waitcnt lgkmcnt(3)
    v_mfma_f32_16x16x32_bf16 v[116:119], v[32:35], v[12:15], v[116:119]
    v_mfma_f32_16x16x32_bf16 v[120:123], v[32:35], v[16:19], v[120:123]
    ds_read_b128 v[32:35], v10 offset:13312
    s_add_u32 s45, s45, 22528
    s_cmp_ge_u32 s45, 157696
    s_cselect_b32 s30, 157696, 0
    s_sub_u32 s45, s45, s30
    s_barrier
    v_add_u32 v9, s45, v7
    v_add_u32 v10, s45, v8
    ds_read_b128 v[20:23], v9 offset:0
    ds_read_b128 v[24:27], v9 offset:256
    s_waitcnt lgkmcnt(5)
    v_mfma_f32_16x16x32_bf16 v[124:127], v[36:39], v[12:15], v[124:127]
    v_mfma_f32_16x16x32_bf16 v[128:131], v[36:39], v[16:19], v[128:131]
    ds_read_b128 v[36:39], v10 offset:0
    s_waitcnt lgkmcnt(5)
    v_mfma_f32_16x16x32_bf16 v[132:135], v[40:43], v[12:15], v[132:135]
    v_mfma_f32_16x16x32_bf16 v[136:139], v[40:43], v[16:19], v[136:139]
    ds_read_b128 v[40:43], v10 offset:1024
    s_waitcnt lgkmcnt(5)
    v_mfma_f32_16x16x32_bf16 v[140:143], v[28:31], v[12:15], v[140:143]
    v_mfma_f32_16x16x32_bf16 v[144:147], v[28:31], v[16:19], v[144:147]
    ds_read_b128 v[28:31], v10 offset:2048
    s_waitcnt lgkmcnt(5)
    v_mfma_f32_16x16x32_bf16 v[148:151], v[32:35], v[12:15], v[148:151]
    v_mfma_f32_16x16x32_bf16 v[152:155], v[32:35], v[16:19], v[152:155]
    ds_read_b128 v[32:35], v10 offset:3072
    s_waitcnt lgkmcnt(3)
    v_mfma_f32_16x16x32_bf16 v[44:47], v[36:39], v[20:23], v[44:47]
    v_mfma_f32_16x16x32_bf16 v[48:51], v[36:39], v[24:27], v[48:51]
    ds_read_b128 v[36:39], v10 offset:4096
    s_waitcnt lgkmcnt(3)
    v_mfma_f32_16x16x32_bf16 v[52:55], v[40:43], v[20:23], v[52:55]
    v_mfma_f32_16x16x32_bf16 v[56:59], v[40:43], v[24:27], v[56:59]
    ds_read_b128 v[40:43], v10 offset:5120
    s_waitcnt lgkmcnt(3)
    v_mfma_f32_16x16x32_bf16 v[60:63], v[28:31], v[20:23], v[60:63]
    v_mfma_f32_16x16x32_bf16 v[64:67], v[28:31], v[24:27], v[64:67]
    ds_read_b128 v[28:31], v10 offset:6144
    s_waitcnt lgkmcnt(3)
    v_mfma_f32_16x16x32_bf16 v[68:71], v[32:35], v[20:23], v[68:71]
    v_mfma_f32_16x16x32_bf16 v[72:75], v[32:35], v[24:27], v[72:75]
    ds_read_b128 v[32:35], v10 offset:7168
    s_waitcnt lgkmcnt(3)
    v_mfma_f32_16x16x32_bf16 v[76:79], v[36:39], v[20:23], v[76:79]
    v_mfma_f32_16x16x32_bf16 v[80:83], v[36:39], v[24:27], v[80:83]
    ds_read_b128 v[36:39], v10 offset:8192
    s_waitcnt lgkmcnt(3)
    v_mfma_f32_16x16x32_bf16 v[84:87], v[40:43], v[20:23], v[84:87]
    v_mfma_f32_16x16x32_bf16 v[88:91], v[40:43], v[24:27], v[88:91]
    ds_read_b128 v[40:43], v10 offset:9216
    s_waitcnt lgkmcnt(3)
    v_mfma_f32_16x16x32_bf16 v[92:95], v[28:31], v[20:23], v[92:95]
    v_mfma_f32_16x16x32_bf16 v[96:99], v[28:31], v[24:27], v[96:99]
    ds_read_b128 v[28:31], v10 offset:10240
    s_waitcnt lgkmcnt(3)
    v_mfma_f32_16x16x32_bf16 v[100:103], v[32:35], v[20:23], v[100:103]
    v_mfma_f32_16x16x32_bf16 v[104:107], v[32:35], v[24:27], v[104:107]
    ds_read_b128 v[32:35], v10 offset:11264
    s_waitcnt lgkmcnt(3)
    v_mfma_f32_16x16x32_bf16 v[108:111], v[36:39], v[20:23], v[108:111]
    v_mfma_f32_16x16x32_bf16 v[112:115], v[36:39], v[24:27], v[112:115]
    ds_read_b128 v[36:39], v10 offset:12288
    s_waitcnt lgkmcnt(3)
    v_mfma_f32_16x16x32_bf16 v[116:119], v[40:43], v[20:23], v[116:119]
    v_mfma_f32_16x16x32_bf16 v[120:123], v[40:43], v[24:27], v[120:123]
    ds_read_b128 v[40:43], v10 offset:13312
    s_add_u32 s49, s49, 1
    s_cmp_ge_u32 s49, 10
    s_cbranch_scc1 gu_kernel_tail
    s_add_u32 s45, s45, 22528
    s_cmp_ge_u32 s45, 157696
    s_cselect_b32 s30, 157696, 0
    s_sub_u32 s45, s45, s30
    s_barrier
    v_add_u32 v9, s45, v7
    v_add_u32 v10, s45, v8
    ds_read_b128 v[12:15], v9 offset:0
    ds_read_b128 v[16:19], v9 offset:256
    s_waitcnt lgkmcnt(5)
    v_mfma_f32_16x16x32_bf16 v[124:127], v[28:31], v[20:23], v[124:127]
    v_mfma_f32_16x16x32_bf16 v[128:131], v[28:31], v[24:27], v[128:131]
    ds_read_b128 v[28:31], v10 offset:0
    s_waitcnt lgkmcnt(5)
    v_mfma_f32_16x16x32_bf16 v[132:135], v[32:35], v[20:23], v[132:135]
    v_mfma_f32_16x16x32_bf16 v[136:139], v[32:35], v[24:27], v[136:139]
    ds_read_b128 v[32:35], v10 offset:1024
    s_waitcnt lgkmcnt(5)
    v_mfma_f32_16x16x32_bf16 v[140:143], v[36:39], v[20:23], v[140:143]
    v_mfma_f32_16x16x32_bf16 v[144:147], v[36:39], v[24:27], v[144:147]
    ds_read_b128 v[36:39], v10 offset:2048
    s_waitcnt lgkmcnt(5)
    v_mfma_f32_16x16x32_bf16 v[148:151], v[40:43], v[20:23], v[148:151]
    v_mfma_f32_16x16x32_bf16 v[152:155], v[40:43], v[24:27], v[152:155]
    ds_read_b128 v[40:43], v10 offset:3072
    s_branch gu_kernel_loop
gu_kernel_tail:
    s_waitcnt lgkmcnt(0)
    v_mfma_f32_16x16x32_bf16 v[124:127], v[28:31], v[20:23], v[124:127]
    v_mfma_f32_16x16x32_bf16 v[128:131], v[28:31], v[24:27], v[128:131]
    v_mfma_f32_16x16x32_bf16 v[132:135], v[32:35], v[20:23], v[132:135]
    v_mfma_f32_16x16x32_bf16 v[136:139], v[32:35], v[24:27], v[136:139]
    v_mfma_f32_16x16x32_bf16 v[140:143], v[36:39], v[20:23], v[140:143]
    v_mfma_f32_16x16x32_bf16 v[144:147], v[36:39], v[24:27], v[144:147]
    v_mfma_f32_16x16x32_bf16 v[148:151], v[40:43], v[20:23], v[148:151]
    v_mfma_f32_16x16x32_bf16 v[152:155], v[40:43], v[24:27], v[152:155]
    s_waitcnt vmcnt(0)
    v_add_f32 v216, v216, v218
    v_add_f32 v217, v217, v219
    v_mov_b32 v3, v216
    s_nop 1
    v_permlane32_swap_b32 v3, v216
    s_nop 1
    v_add_f32 v216, v216, v3
    v_mov_b32 v3, v216
    s_nop 1
    v_permlane16_swap_b32 v3, v216
    s_nop 1
    v_add_f32 v216, v216, v3
    v_mov_b32 v3, v217
    s_nop 1
    v_permlane32_swap_b32 v3, v217
    s_nop 1
    v_add_f32 v217, v217, v3
    v_mov_b32 v3, v217
    s_nop 1
    v_permlane16_swap_b32 v3, v217
    s_nop 1
    v_add_f32 v217, v217, v3
    s_mov_b32 s30, 986500301
    v_mul_f32 v224, s30, v216
    v_mul_f32 v217, s30, v217
    v_fma_f32 v217, -v224, v224, v217
    v_max_f32 v217, 0, v217
    v_add_f32 v217, 925353388, v217
    v_rsq_f32 v228, v217
    v_sub_f32 v224, 0, v224
    v_add_f32 v220, v220, v222
    v_add_f32 v221, v221, v223
    v_mov_b32 v3, v220
    s_nop 1
    v_permlane32_swap_b32 v3, v220
    s_nop 1
    v_add_f32 v220, v220, v3
    v_mov_b32 v3, v220
    s_nop 1
    v_permlane16_swap_b32 v3, v220
    s_nop 1
    v_add_f32 v220, v220, v3
    v_mov_b32 v3, v221
    s_nop 1
    v_permlane32_swap_b32 v3, v221
    s_nop 1
    v_add_f32 v221, v221, v3
    v_mov_b32 v3, v221
    s_nop 1
    v_permlane16_swap_b32 v3, v221
    s_nop 1
    v_add_f32 v221, v221, v3
    s_mov_b32 s30, 986500301
    v_mul_f32 v226, s30, v220
    v_mul_f32 v221, s30, v221
    v_fma_f32 v221, -v226, v226, v221
    v_max_f32 v221, 0, v221
    v_add_f32 v221, 925353388, v221
    v_rsq_f32 v229, v221
    v_sub_f32 v226, 0, v226
    v_mul_f32 v230, 3216550459, v228
    v_mul_f32 v232, 3216550459, v229
    v_mov_b32 v250, 1.0
    v_mov_b32 v251, 1.0
    v_and_b32 v3, 63, v157
    v_and_b32 v4, 1, v156
    v_lshl_add_u32 v3, v4, 4, v3
    v_lshlrev_b32 v3, 4, v3
    v_lshrrev_b32 v4, 1, v156
    v_lshl_add_u32 v240, v4, 10, v3
    s_mul_i32 s30, s17, 14336
    s_mul_i32 s31, s29, 221184
    s_add_u32 s30, s30, s31
    v_pk_fma_f32 v[44:45], v[160:161], v[224:225], v[44:45] op_sel_hi:[1,0,1]
    v_pk_fma_f32 v[46:47], v[162:163], v[224:225], v[46:47] op_sel_hi:[1,0,1]
    v_pk_mul_f32 v[242:243], v[44:45], v[230:231] op_sel_hi:[1,0]
    v_pk_mul_f32 v[244:245], v[46:47], v[230:231] op_sel_hi:[1,0]
    v_exp_f32 v246, v242
    v_exp_f32 v247, v243
    v_exp_f32 v248, v244
    v_exp_f32 v249, v245
    v_pk_fma_f32 v[100:101], v[188:189], v[224:225], v[100:101] op_sel_hi:[1,0,1]
    v_pk_fma_f32 v[102:103], v[190:191], v[224:225], v[102:103] op_sel_hi:[1,0,1]
    v_pk_add_f32 v[246:247], v[246:247], v[250:251]
    v_pk_add_f32 v[248:249], v[248:249], v[250:251]
    v_rcp_f32 v246, v246
    v_rcp_f32 v247, v247
    v_rcp_f32 v248, v248
    v_rcp_f32 v249, v249
    v_pk_mul_f32 v[242:243], v[242:243], v[100:101]
    v_pk_mul_f32 v[244:245], v[244:245], v[102:103]
    v_pk_mul_f32 v[242:243], v[242:243], v[246:247]
    v_pk_mul_f32 v[244:245], v[244:245], v[248:249]
    v_cvt_pk_bf16_f32 v236, v242, v243
    v_cvt_pk_bf16_f32 v237, v244, v245
    v_pk_fma_f32 v[48:49], v[160:161], v[226:227], v[48:49] op_sel_hi:[1,0,1]
    v_pk_fma_f32 v[50:51], v[162:163], v[226:227], v[50:51] op_sel_hi:[1,0,1]
    v_pk_mul_f32 v[242:243], v[48:49], v[232:233] op_sel_hi:[1,0]
    v_pk_mul_f32 v[244:245], v[50:51], v[232:233] op_sel_hi:[1,0]
    v_exp_f32 v246, v242
    v_exp_f32 v247, v243
    v_exp_f32 v248, v244
    v_exp_f32 v249, v245
    v_pk_fma_f32 v[104:105], v[188:189], v[226:227], v[104:105] op_sel_hi:[1,0,1]
    v_pk_fma_f32 v[106:107], v[190:191], v[226:227], v[106:107] op_sel_hi:[1,0,1]
    v_pk_add_f32 v[246:247], v[246:247], v[250:251]
    v_pk_add_f32 v[248:249], v[248:249], v[250:251]
    v_rcp_f32 v246, v246
    v_rcp_f32 v247, v247
    v_rcp_f32 v248, v248
    v_rcp_f32 v249, v249
    v_pk_mul_f32 v[242:243], v[242:243], v[104:105]
    v_pk_mul_f32 v[244:245], v[244:245], v[106:107]
    v_pk_mul_f32 v[242:243], v[242:243], v[246:247]
    v_pk_mul_f32 v[244:245], v[244:245], v[248:249]
    v_cvt_pk_bf16_f32 v238, v242, v243
    v_cvt_pk_bf16_f32 v239, v244, v245
    s_nop 1
    v_permlane16_swap_b32 v236, v238
    v_permlane16_swap_b32 v237, v239
    s_add_u32 s31, s30, 0
    buffer_store_dwordx4 v[236:239], v240, s[12:15], s31 offen sc1
    s_nop 1
    v_pk_fma_f32 v[52:53], v[164:165], v[224:225], v[52:53] op_sel_hi:[1,0,1]
    v_pk_fma_f32 v[54:55], v[166:167], v[224:225], v[54:55] op_sel_hi:[1,0,1]
    v_pk_mul_f32 v[242:243], v[52:53], v[230:231] op_sel_hi:[1,0]
    v_pk_mul_f32 v[244:245], v[54:55], v[230:231] op_sel_hi:[1,0]
    v_exp_f32 v246, v242
    v_exp_f32 v247, v243
    v_exp_f32 v248, v244
    v_exp_f32 v249, v245
    v_pk_fma_f32 v[108:109], v[192:193], v[224:225], v[108:109] op_sel_hi:[1,0,1]
    v_pk_fma_f32 v[110:111], v[194:195], v[224:225], v[110:111] op_sel_hi:[1,0,1]
    v_pk_add_f32 v[246:247], v[246:247], v[250:251]
    v_pk_add_f32 v[248:249], v[248:249], v[250:251]
    v_rcp_f32 v246, v246
    v_rcp_f32 v247, v247
    v_rcp_f32 v248, v248
    v_rcp_f32 v249, v249
    v_pk_mul_f32 v[242:243], v[242:243], v[108:109]
    v_pk_mul_f32 v[244:245], v[244:245], v[110:111]
    v_pk_mul_f32 v[242:243], v[242:243], v[246:247]
    v_pk_mul_f32 v[244:245], v[244:245], v[248:249]
    v_cvt_pk_bf16_f32 v236, v242, v243
    v_cvt_pk_bf16_f32 v237, v244, v245
    v_pk_fma_f32 v[56:57], v[164:165], v[226:227], v[56:57] op_sel_hi:[1,0,1]
    v_pk_fma_f32 v[58:59], v[166:167], v[226:227], v[58:59] op_sel_hi:[1,0,1]
    v_pk_mul_f32 v[242:243], v[56:57], v[232:233] op_sel_hi:[1,0]
    v_pk_mul_f32 v[244:245], v[58:59], v[232:233] op_sel_hi:[1,0]
    v_exp_f32 v246, v242
    v_exp_f32 v247, v243
    v_exp_f32 v248, v244
    v_exp_f32 v249, v245
    v_pk_fma_f32 v[112:113], v[192:193], v[226:227], v[112:113] op_sel_hi:[1,0,1]
    v_pk_fma_f32 v[114:115], v[194:195], v[226:227], v[114:115] op_sel_hi:[1,0,1]
    v_pk_add_f32 v[246:247], v[246:247], v[250:251]
    v_pk_add_f32 v[248:249], v[248:249], v[250:251]
    v_rcp_f32 v246, v246
    v_rcp_f32 v247, v247
    v_rcp_f32 v248, v248
    v_rcp_f32 v249, v249
    v_pk_mul_f32 v[242:243], v[242:243], v[112:113]
    v_pk_mul_f32 v[244:245], v[244:245], v[114:115]
    v_pk_mul_f32 v[242:243], v[242:243], v[246:247]
    v_pk_mul_f32 v[244:245], v[244:245], v[248:249]
    v_cvt_pk_bf16_f32 v238, v242, v243
    v_cvt_pk_bf16_f32 v239, v244, v245
    s_nop 1
    v_permlane16_swap_b32 v236, v238
    v_permlane16_swap_b32 v237, v239
    s_add_u32 s31, s30, 2048
    buffer_store_dwordx4 v[236:239], v240, s[12:15], s31 offen sc1
    s_nop 1
    v_pk_fma_f32 v[60:61], v[168:169], v[224:225], v[60:61] op_sel_hi:[1,0,1]
    v_pk_fma_f32 v[62:63], v[170:171], v[224:225], v[62:63] op_sel_hi:[1,0,1]
    v_pk_mul_f32 v[242:243], v[60:61], v[230:231] op_sel_hi:[1,0]
    v_pk_mul_f32 v[244:245], v[62:63], v[230:231] op_sel_hi:[1,0]
    v_exp_f32 v246, v242
    v_exp_f32 v247, v243
    v_exp_f32 v248, v244
    v_exp_f32 v249, v245
    v_pk_fma_f32 v[116:117], v[196:197], v[224:225], v[116:117] op_sel_hi:[1,0,1]
    v_pk_fma_f32 v[118:119], v[198:199], v[224:225], v[118:119] op_sel_hi:[1,0,1]
    v_pk_add_f32 v[246:247], v[246:247], v[250:251]
    v_pk_add_f32 v[248:249], v[248:249], v[250:251]
    v_rcp_f32 v246, v246
    v_rcp_f32 v247, v247
    v_rcp_f32 v248, v248
    v_rcp_f32 v249, v249
    v_pk_mul_f32 v[242:243], v[242:243], v[116:117]
    v_pk_mul_f32 v[244:245], v[244:245], v[118:119]
    v_pk_mul_f32 v[242:243], v[242:243], v[246:247]
    v_pk_mul_f32 v[244:245], v[244:245], v[248:249]
    v_cvt_pk_bf16_f32 v236, v242, v243
    v_cvt_pk_bf16_f32 v237, v244, v245
    v_pk_fma_f32 v[64:65], v[168:169], v[226:227], v[64:65] op_sel_hi:[1,0,1]
    v_pk_fma_f32 v[66:67], v[170:171], v[226:227], v[66:67] op_sel_hi:[1,0,1]
    v_pk_mul_f32 v[242:243], v[64:65], v[232:233] op_sel_hi:[1,0]
    v_pk_mul_f32 v[244:245], v[66:67], v[232:233] op_sel_hi:[1,0]
    v_exp_f32 v246, v242
    v_exp_f32 v247, v243
    v_exp_f32 v248, v244
    v_exp_f32 v249, v245
    v_pk_fma_f32 v[120:121], v[196:197], v[226:227], v[120:121] op_sel_hi:[1,0,1]
    v_pk_fma_f32 v[122:123], v[198:199], v[226:227], v[122:123] op_sel_hi:[1,0,1]
    v_pk_add_f32 v[246:247], v[246:247], v[250:251]
    v_pk_add_f32 v[248:249], v[248:249], v[250:251]
    v_rcp_f32 v246, v246
    v_rcp_f32 v247, v247
    v_rcp_f32 v248, v248
    v_rcp_f32 v249, v249
    v_pk_mul_f32 v[242:243], v[242:243], v[120:121]
    v_pk_mul_f32 v[244:245], v[244:245], v[122:123]
    v_pk_mul_f32 v[242:243], v[242:243], v[246:247]
    v_pk_mul_f32 v[244:245], v[244:245], v[248:249]
    v_cvt_pk_bf16_f32 v238, v242, v243
    v_cvt_pk_bf16_f32 v239, v244, v245
    s_nop 1
    v_permlane16_swap_b32 v236, v238
    v_permlane16_swap_b32 v237, v239
    s_add_u32 s31, s30, 4096
    buffer_store_dwordx4 v[236:239], v240, s[12:15], s31 offen sc1
    s_nop 1
    s_cmp_eq_u32 s17, 15
    s_cbranch_scc1 gu_kernel_end
    v_pk_fma_f32 v[68:69], v[172:173], v[224:225], v[68:69] op_sel_hi:[1,0,1]
    v_pk_fma_f32 v[70:71], v[174:175], v[224:225], v[70:71] op_sel_hi:[1,0,1]
    v_pk_mul_f32 v[242:243], v[68:69], v[230:231] op_sel_hi:[1,0]
    v_pk_mul_f32 v[244:245], v[70:71], v[230:231] op_sel_hi:[1,0]
    v_exp_f32 v246, v242
    v_exp_f32 v247, v243
    v_exp_f32 v248, v244
    v_exp_f32 v249, v245
    v_pk_fma_f32 v[124:125], v[200:201], v[224:225], v[124:125] op_sel_hi:[1,0,1]
    v_pk_fma_f32 v[126:127], v[202:203], v[224:225], v[126:127] op_sel_hi:[1,0,1]
    v_pk_add_f32 v[246:247], v[246:247], v[250:251]
    v_pk_add_f32 v[248:249], v[248:249], v[250:251]
    v_rcp_f32 v246, v246
    v_rcp_f32 v247, v247
    v_rcp_f32 v248, v248
    v_rcp_f32 v249, v249
    v_pk_mul_f32 v[242:243], v[242:243], v[124:125]
    v_pk_mul_f32 v[244:245], v[244:245], v[126:127]
    v_pk_mul_f32 v[242:243], v[242:243], v[246:247]
    v_pk_mul_f32 v[244:245], v[244:245], v[248:249]
    v_cvt_pk_bf16_f32 v236, v242, v243
    v_cvt_pk_bf16_f32 v237, v244, v245
    v_pk_fma_f32 v[72:73], v[172:173], v[226:227], v[72:73] op_sel_hi:[1,0,1]
    v_pk_fma_f32 v[74:75], v[174:175], v[226:227], v[74:75] op_sel_hi:[1,0,1]
    v_pk_mul_f32 v[242:243], v[72:73], v[232:233] op_sel_hi:[1,0]
    v_pk_mul_f32 v[244:245], v[74:75], v[232:233] op_sel_hi:[1,0]
    v_exp_f32 v246, v242
    v_exp_f32 v247, v243
    v_exp_f32 v248, v244
    v_exp_f32 v249, v245
    v_pk_fma_f32 v[128:129], v[200:201], v[226:227], v[128:129] op_sel_hi:[1,0,1]
    v_pk_fma_f32 v[130:131], v[202:203], v[226:227], v[130:131] op_sel_hi:[1,0,1]
    v_pk_add_f32 v[246:247], v[246:247], v[250:251]
    v_pk_add_f32 v[248:249], v[248:249], v[250:251]
    v_rcp_f32 v246, v246
    v_rcp_f32 v247, v247
    v_rcp_f32 v248, v248
    v_rcp_f32 v249, v249
    v_pk_mul_f32 v[242:243], v[242:243], v[128:129]
    v_pk_mul_f32 v[244:245], v[244:245], v[130:131]
    v_pk_mul_f32 v[242:243], v[242:243], v[246:247]
    v_pk_mul_f32 v[244:245], v[244:245], v[248:249]
    v_cvt_pk_bf16_f32 v238, v242, v243
    v_cvt_pk_bf16_f32 v239, v244, v245
    s_nop 1
    v_permlane16_swap_b32 v236, v238
    v_permlane16_swap_b32 v237, v239
    s_add_u32 s31, s30, 6144
    buffer_store_dwordx4 v[236:239], v240, s[12:15], s31 offen sc1
    s_nop 1
    v_pk_fma_f32 v[76:77], v[176:177], v[224:225], v[76:77] op_sel_hi:[1,0,1]
    v_pk_fma_f32 v[78:79], v[178:179], v[224:225], v[78:79] op_sel_hi:[1,0,1]
    v_pk_mul_f32 v[242:243], v[76:77], v[230:231] op_sel_hi:[1,0]
    v_pk_mul_f32 v[244:245], v[78:79], v[230:231] op_sel_hi:[1,0]
    v_exp_f32 v246, v242
    v_exp_f32 v247, v243
    v_exp_f32 v248, v244
    v_exp_f32 v249, v245
    v_pk_fma_f32 v[132:133], v[204:205], v[224:225], v[132:133] op_sel_hi:[1,0,1]
    v_pk_fma_f32 v[134:135], v[206:207], v[224:225], v[134:135] op_sel_hi:[1,0,1]
    v_pk_add_f32 v[246:247], v[246:247], v[250:251]
    v_pk_add_f32 v[248:249], v[248:249], v[250:251]
    v_rcp_f32 v246, v246
    v_rcp_f32 v247, v247
    v_rcp_f32 v248, v248
    v_rcp_f32 v249, v249
    v_pk_mul_f32 v[242:243], v[242:243], v[132:133]
    v_pk_mul_f32 v[244:245], v[244:245], v[134:135]
    v_pk_mul_f32 v[242:243], v[242:243], v[246:247]
    v_pk_mul_f32 v[244:245], v[244:245], v[248:249]
    v_cvt_pk_bf16_f32 v236, v242, v243
    v_cvt_pk_bf16_f32 v237, v244, v245
    v_pk_fma_f32 v[80:81], v[176:177], v[226:227], v[80:81] op_sel_hi:[1,0,1]
    v_pk_fma_f32 v[82:83], v[178:179], v[226:227], v[82:83] op_sel_hi:[1,0,1]
    v_pk_mul_f32 v[242:243], v[80:81], v[232:233] op_sel_hi:[1,0]
    v_pk_mul_f32 v[244:245], v[82:83], v[232:233] op_sel_hi:[1,0]
    v_exp_f32 v246, v242
    v_exp_f32 v247, v243
    v_exp_f32 v248, v244
    v_exp_f32 v249, v245
    v_pk_fma_f32 v[136:137], v[204:205], v[226:227], v[136:137] op_sel_hi:[1,0,1]
    v_pk_fma_f32 v[138:139], v[206:207], v[226:227], v[138:139] op_sel_hi:[1,0,1]
    v_pk_add_f32 v[246:247], v[246:247], v[250:251]
    v_pk_add_f32 v[248:249], v[248:249], v[250:251]
    v_rcp_f32 v246, v246
    v_rcp_f32 v247, v247
    v_rcp_f32 v248, v248
    v_rcp_f32 v249, v249
    v_pk_mul_f32 v[242:243], v[242:243], v[136:137]
    v_pk_mul_f32 v[244:245], v[244:245], v[138:139]
    v_pk_mul_f32 v[242:243], v[242:243], v[246:247]
    v_pk_mul_f32 v[244:245], v[244:245], v[248:249]
    v_cvt_pk_bf16_f32 v238, v242, v243
    v_cvt_pk_bf16_f32 v239, v244, v245
    s_nop 1
    v_permlane16_swap_b32 v236, v238
    v_permlane16_swap_b32 v237, v239
    s_add_u32 s31, s30, 8192
    buffer_store_dwordx4 v[236:239], v240, s[12:15], s31 offen sc1
    s_nop 1
    v_pk_fma_f32 v[84:85], v[180:181], v[224:225], v[84:85] op_sel_hi:[1,0,1]
    v_pk_fma_f32 v[86:87], v[182:183], v[224:225], v[86:87] op_sel_hi:[1,0,1]
    v_pk_mul_f32 v[242:243], v[84:85], v[230:231] op_sel_hi:[1,0]
    v_pk_mul_f32 v[244:245], v[86:87], v[230:231] op_sel_hi:[1,0]
    v_exp_f32 v246, v242
    v_exp_f32 v247, v243
    v_exp_f32 v248, v244
    v_exp_f32 v249, v245
    v_pk_fma_f32 v[140:141], v[208:209], v[224:225], v[140:141] op_sel_hi:[1,0,1]
    v_pk_fma_f32 v[142:143], v[210:211], v[224:225], v[142:143] op_sel_hi:[1,0,1]
    v_pk_add_f32 v[246:247], v[246:247], v[250:251]
    v_pk_add_f32 v[248:249], v[248:249], v[250:251]
    v_rcp_f32 v246, v246
    v_rcp_f32 v247, v247
    v_rcp_f32 v248, v248
    v_rcp_f32 v249, v249
    v_pk_mul_f32 v[242:243], v[242:243], v[140:141]
    v_pk_mul_f32 v[244:245], v[244:245], v[142:143]
    v_pk_mul_f32 v[242:243], v[242:243], v[246:247]
    v_pk_mul_f32 v[244:245], v[244:245], v[248:249]
    v_cvt_pk_bf16_f32 v236, v242, v243
    v_cvt_pk_bf16_f32 v237, v244, v245
    v_pk_fma_f32 v[88:89], v[180:181], v[226:227], v[88:89] op_sel_hi:[1,0,1]
    v_pk_fma_f32 v[90:91], v[182:183], v[226:227], v[90:91] op_sel_hi:[1,0,1]
    v_pk_mul_f32 v[242:243], v[88:89], v[232:233] op_sel_hi:[1,0]
    v_pk_mul_f32 v[244:245], v[90:91], v[232:233] op_sel_hi:[1,0]
    v_exp_f32 v246, v242
    v_exp_f32 v247, v243
    v_exp_f32 v248, v244
    v_exp_f32 v249, v245
    v_pk_fma_f32 v[144:145], v[208:209], v[226:227], v[144:145] op_sel_hi:[1,0,1]
    v_pk_fma_f32 v[146:147], v[210:211], v[226:227], v[146:147] op_sel_hi:[1,0,1]
    v_pk_add_f32 v[246:247], v[246:247], v[250:251]
    v_pk_add_f32 v[248:249], v[248:249], v[250:251]
    v_rcp_f32 v246, v246
    v_rcp_f32 v247, v247
    v_rcp_f32 v248, v248
    v_rcp_f32 v249, v249
    v_pk_mul_f32 v[242:243], v[242:243], v[144:145]
    v_pk_mul_f32 v[244:245], v[244:245], v[146:147]
    v_pk_mul_f32 v[242:243], v[242:243], v[246:247]
    v_pk_mul_f32 v[244:245], v[244:245], v[248:249]
    v_cvt_pk_bf16_f32 v238, v242, v243
    v_cvt_pk_bf16_f32 v239, v244, v245
    s_nop 1
    v_permlane16_swap_b32 v236, v238
    v_permlane16_swap_b32 v237, v239
    s_add_u32 s31, s30, 10240
    buffer_store_dwordx4 v[236:239], v240, s[12:15], s31 offen sc1
    s_nop 1
    v_pk_fma_f32 v[92:93], v[184:185], v[224:225], v[92:93] op_sel_hi:[1,0,1]
    v_pk_fma_f32 v[94:95], v[186:187], v[224:225], v[94:95] op_sel_hi:[1,0,1]
    v_pk_mul_f32 v[242:243], v[92:93], v[230:231] op_sel_hi:[1,0]
    v_pk_mul_f32 v[244:245], v[94:95], v[230:231] op_sel_hi:[1,0]
    v_exp_f32 v246, v242
    v_exp_f32 v247, v243
    v_exp_f32 v248, v244
    v_exp_f32 v249, v245
    v_pk_fma_f32 v[148:149], v[212:213], v[224:225], v[148:149] op_sel_hi:[1,0,1]
    v_pk_fma_f32 v[150:151], v[214:215], v[224:225], v[150:151] op_sel_hi:[1,0,1]
    v_pk_add_f32 v[246:247], v[246:247], v[250:251]
    v_pk_add_f32 v[248:249], v[248:249], v[250:251]
    v_rcp_f32 v246, v246
    v_rcp_f32 v247, v247
    v_rcp_f32 v248, v248
    v_rcp_f32 v249, v249
    v_pk_mul_f32 v[242:243], v[242:243], v[148:149]
    v_pk_mul_f32 v[244:245], v[244:245], v[150:151]
    v_pk_mul_f32 v[242:243], v[242:243], v[246:247]
    v_pk_mul_f32 v[244:245], v[244:245], v[248:249]
    v_cvt_pk_bf16_f32 v236, v242, v243
    v_cvt_pk_bf16_f32 v237, v244, v245
    v_pk_fma_f32 v[96:97], v[184:185], v[226:227], v[96:97] op_sel_hi:[1,0,1]
    v_pk_fma_f32 v[98:99], v[186:187], v[226:227], v[98:99] op_sel_hi:[1,0,1]
    v_pk_mul_f32 v[242:243], v[96:97], v[232:233] op_sel_hi:[1,0]
    v_pk_mul_f32 v[244:245], v[98:99], v[232:233] op_sel_hi:[1,0]
    v_exp_f32 v246, v242
    v_exp_f32 v247, v243
    v_exp_f32 v248, v244
    v_exp_f32 v249, v245
    v_pk_fma_f32 v[152:153], v[212:213], v[226:227], v[152:153] op_sel_hi:[1,0,1]
    v_pk_fma_f32 v[154:155], v[214:215], v[226:227], v[154:155] op_sel_hi:[1,0,1]
    v_pk_add_f32 v[246:247], v[246:247], v[250:251]
    v_pk_add_f32 v[248:249], v[248:249], v[250:251]
    v_rcp_f32 v246, v246
    v_rcp_f32 v247, v247
    v_rcp_f32 v248, v248
    v_rcp_f32 v249, v249
    v_pk_mul_f32 v[242:243], v[242:243], v[152:153]
    v_pk_mul_f32 v[244:245], v[244:245], v[154:155]
    v_pk_mul_f32 v[242:243], v[242:243], v[246:247]
    v_pk_mul_f32 v[244:245], v[244:245], v[248:249]
    v_cvt_pk_bf16_f32 v238, v242, v243
    v_cvt_pk_bf16_f32 v239, v244, v245
    s_nop 1
    v_permlane16_swap_b32 v236, v238
    v_permlane16_swap_b32 v237, v239
    s_add_u32 s31, s30, 12288
    buffer_store_dwordx4 v[236:239], v240, s[12:15], s31 offen sc1
    s_nop 1
    s_branch gu_kernel_end
gu_kernel_end:
    s_endpgm
.globl down_kernel
.p2align 8
.type down_kernel,@function
down_kernel:
    s_cmp_ge_u32 s2, 256
    s_cbranch_scc1 down_kernel_end
    s_load_dwordx16 s[64:79], s[0:1], 0
    s_load_dwordx4 s[80:83], s[0:1], 64
    v_lshrrev_b32 v1, 6, v0
    v_and_b32 v2, 63, v0
    v_readfirstlane_b32 s18, v1
    s_and_b32 s35, s2, 7
    s_lshr_b32 s31, s2, 3
    s_and_b32 s32, s31, 7
    s_lshr_b32 s33, s31, 3
    s_lshr_b32 s34, s35, 1
    s_lshl_b32 s34, s34, 3
    s_add_u32 s16, s34, s32
    s_and_b32 s34, s35, 1
    s_lshl_b32 s34, s34, 2
    s_add_u32 s17, s34, s33
    s_mul_i32 s28, s17, 160
    s_cmp_ge_u32 s18, 4
    s_cbranch_scc0 down_kernel_main_loader
    s_sub_u32 s18, s18, 4
    v_lshlrev_b32 v3, 4, v2
    s_mul_i32 s50, s18, 2048
    s_mul_i32 s30, s16, 221184
    s_add_u32 s50, s50, s30
    s_mul_i32 s25, s18, 2048
    s_lshl_b32 s27, s18, 10
    s_add_u32 s27, s27, 8192
    s_mul_i32 s51, s17, 276480
    s_lshl_b32 s30, s18, 10
    s_add_u32 s51, s51, s30
    s_add_u32 s51, s51, 5406720
    s_mul_i32 s30, s32, 3
    s_mul_i32 s31, s33, 7
    s_add_u32 s44, s30, s31
    s_cmp_ge_u32 s44, 27
    s_cselect_b32 s30, 27, 0
    s_sub_u32 s44, s44, s30
    s_cmp_ge_u32 s44, 27
    s_cselect_b32 s30, 27, 0
    s_sub_u32 s44, s44, s30
    s_mov_b32 s46, 0
    s_waitcnt lgkmcnt(0)
    s_add_u32 s4, s82, 13107200
    s_addc_u32 s5, s83, 0
    s_mov_b32 s6, 7077888
    s_mov_b32 s7, 0x00020000
    s_add_u32 s8, s82, 20332544
    s_addc_u32 s9, s83, 0
    s_mov_b32 s10, 7618560
    s_mov_b32 s11, 0x00020000
    s_mul_i32 s47, s44, 8192
    s_add_u32 s47, s47, s50
    s_mul_i32 s48, s44, 10240
    s_add_u32 s48, s48, s51
    s_add_u32 s52, s27, s46
    s_add_u32 s53, s25, s46
    s_add_u32 m0, s52, 0
    s_add_u32 s31, s48, 0
    buffer_load_dwordx4 v3, s[8:11], s31 offen lds
    s_add_u32 m0, s52, 4096
    s_add_u32 s31, s48, 4096
    buffer_load_dwordx4 v3, s[8:11], s31 offen lds
    s_cmp_ge_u32 s18, 2
    s_cbranch_scc1 down_kernel_sk_1
    s_add_u32 m0, s52, 8192
    s_add_u32 s31, s48, 8192
    buffer_load_dwordx4 v3, s[8:11], s31 offen lds
down_kernel_sk_1:
    s_add_u32 m0, s53, 0
    s_add_u32 s31, s47, 0
    buffer_load_dwordx4 v3, s[4:7], s31 offen lds
    s_add_u32 m0, s53, 1024
    s_add_u32 s31, s47, 1024
    buffer_load_dwordx4 v3, s[4:7], s31 offen lds
    s_add_u32 s44, s44, 1
    s_cmp_ge_u32 s44, 27
    s_cselect_b32 s30, 27, 0
    s_sub_u32 s44, s44, s30
    s_add_u32 s46, s46, 18432
    s_cmp_ge_u32 s46, 147456
    s_cselect_b32 s30, 147456, 0
    s_sub_u32 s46, s46, s30
    s_mul_i32 s47, s44, 8192
    s_add_u32 s47, s47, s50
    s_mul_i32 s48, s44, 10240
    s_add_u32 s48, s48, s51
    s_add_u32 s52, s27, s46
    s_add_u32 s53, s25, s46
    s_add_u32 m0, s52, 0
    s_add_u32 s31, s48, 0
    buffer_load_dwordx4 v3, s[8:11], s31 offen lds
    s_add_u32 m0, s52, 4096
    s_add_u32 s31, s48, 4096
    buffer_load_dwordx4 v3, s[8:11], s31 offen lds
    s_cmp_ge_u32 s18, 2
    s_cbranch_scc1 down_kernel_sk_2
    s_add_u32 m0, s52, 8192
    s_add_u32 s31, s48, 8192
    buffer_load_dwordx4 v3, s[8:11], s31 offen lds
down_kernel_sk_2:
    s_add_u32 m0, s53, 0
    s_add_u32 s31, s47, 0
    buffer_load_dwordx4 v3, s[4:7], s31 offen lds
    s_add_u32 m0, s53, 1024
    s_add_u32 s31, s47, 1024
    buffer_load_dwordx4 v3, s[4:7], s31 offen lds
    s_add_u32 s44, s44, 1
    s_cmp_ge_u32 s44, 27
    s_cselect_b32 s30, 27, 0
    s_sub_u32 s44, s44, s30
    s_add_u32 s46, s46, 18432
    s_cmp_ge_u32 s46, 147456
    s_cselect_b32 s30, 147456, 0
    s_sub_u32 s46, s46, s30
    s_cmp_ge_u32 s18, 2
    s_cbranch_scc1 down_kernel_w_3
    s_waitcnt vmcnt(5)
    s_branch down_kernel_w_4
down_kernel_w_3:
    s_waitcnt vmcnt(4)
down_kernel_w_4:
    s_barrier
    s_mul_i32 s47, s44, 8192
    s_add_u32 s47, s47, s50
    s_mul_i32 s48, s44, 10240
    s_add_u32 s48, s48, s51
    s_add_u32 s52, s27, s46
    s_add_u32 s53, s25, s46
    s_add_u32 m0, s52, 0
    s_add_u32 s31, s48, 0
    buffer_load_dwordx4 v3, s[8:11], s31 offen lds
    s_add_u32 m0, s52, 4096
    s_add_u32 s31, s48, 4096
    buffer_load_dwordx4 v3, s[8:11], s31 offen lds
    s_cmp_ge_u32 s18, 2
    s_cbranch_scc1 down_kernel_sk_5
    s_add_u32 m0, s52, 8192
    s_add_u32 s31, s48, 8192
    buffer_load_dwordx4 v3, s[8:11], s31 offen lds
down_kernel_sk_5:
    s_add_u32 m0, s53, 0
    s_add_u32 s31, s47, 0
    buffer_load_dwordx4 v3, s[4:7], s31 offen lds
    s_add_u32 m0, s53, 1024
    s_add_u32 s31, s47, 1024
    buffer_load_dwordx4 v3, s[4:7], s31 offen lds
    s_add_u32 s44, s44, 1
    s_cmp_ge_u32 s44, 27
    s_cselect_b32 s30, 27, 0
    s_sub_u32 s44, s44, s30
    s_add_u32 s46, s46, 18432
    s_cmp_ge_u32 s46, 147456
    s_cselect_b32 s30, 147456, 0
    s_sub_u32 s46, s46, s30
    s_mul_i32 s47, s44, 8192
    s_add_u32 s47, s47, s50
    s_mul_i32 s48, s44, 10240
    s_add_u32 s48, s48, s51
    s_add_u32 s52, s27, s46
    s_add_u32 s53, s25, s46
    s_add_u32 m0, s52, 0
    s_add_u32 s31, s48, 0
    buffer_load_dwordx4 v3, s[8:11], s31 offen lds
    s_add_u32 m0, s52, 4096
    s_add_u32 s31, s48, 4096
    buffer_load_dwordx4 v3, s[8:11], s31 offen lds
    s_cmp_ge_u32 s18, 2
    s_cbranch_scc1 down_kernel_sk_6
    s_add_u32 m0, s52, 8192
    s_add_u32 s31, s48, 8192
    buffer_load_dwordx4 v3, s[8:11], s31 offen lds
down_kernel_sk_6:
    s_add_u32 m0, s53, 0
    s_add_u32 s31, s47, 0
    buffer_load_dwordx4 v3, s[4:7], s31 offen lds
    s_add_u32 m0, s53, 1024
    s_add_u32 s31, s47, 1024
    buffer_load_dwordx4 v3, s[4:7], s31 offen lds
    s_add_u32 s44, s44, 1
    s_cmp_ge_u32 s44, 27
    s_cselect_b32 s30, 27, 0
    s_sub_u32 s44, s44, s30
    s_add_u32 s46, s46, 18432
    s_cmp_ge_u32 s46, 147456
    s_cselect_b32 s30, 147456, 0
    s_sub_u32 s46, s46, s30
    s_cmp_ge_u32 s18, 2
    s_cbranch_scc1 down_kernel_w_7
    s_waitcnt vmcnt(10)
    s_branch down_kernel_w_8
down_kernel_w_7:
    s_waitcnt vmcnt(8)
down_kernel_w_8:
    s_barrier
    s_mul_i32 s47, s44, 8192
    s_add_u32 s47, s47, s50
    s_mul_i32 s48, s44, 10240
    s_add_u32 s48, s48, s51
    s_add_u32 s52, s27, s46
    s_add_u32 s53, s25, s46
    s_add_u32 m0, s52, 0
    s_add_u32 s31, s48, 0
    buffer_load_dwordx4 v3, s[8:11], s31 offen lds
    s_add_u32 m0, s52, 4096
    s_add_u32 s31, s48, 4096
    buffer_load_dwordx4 v3, s[8:11], s31 offen lds
    s_cmp_ge_u32 s18, 2
    s_cbranch_scc1 down_kernel_sk_9
    s_add_u32 m0, s52, 8192
    s_add_u32 s31, s48, 8192
    buffer_load_dwordx4 v3, s[8:11], s31 offen lds
down_kernel_sk_9:
    s_add_u32 m0, s53, 0
    s_add_u32 s31, s47, 0
    buffer_load_dwordx4 v3, s[4:7], s31 offen lds
    s_add_u32 m0, s53, 1024
    s_add_u32 s31, s47, 1024
    buffer_load_dwordx4 v3, s[4:7], s31 offen lds
    s_add_u32 s44, s44, 1
    s_cmp_ge_u32 s44, 27
    s_cselect_b32 s30, 27, 0
    s_sub_u32 s44, s44, s30
    s_add_u32 s46, s46, 18432
    s_cmp_ge_u32 s46, 147456
    s_cselect_b32 s30, 147456, 0
    s_sub_u32 s46, s46, s30
    s_mul_i32 s47, s44, 8192
    s_add_u32 s47, s47, s50
    s_mul_i32 s48, s44, 10240
    s_add_u32 s48, s48, s51
    s_add_u32 s52, s27, s46
    s_add_u32 s53, s25, s46
    s_add_u32 m0, s52, 0
    s_add_u32 s31, s48, 0
    buffer_load_dwordx4 v3, s[8:11], s31 offen lds
    s_add_u32 m0, s52, 4096
    s_add_u32 s31, s48, 4096
    buffer_load_dwordx4 v3, s[8:11], s31 offen lds
    s_cmp_ge_u32 s18, 2
    s_cbranch_scc1 down_kernel_sk_10
    s_add_u32 m0, s52, 8192
    s_add_u32 s31, s48, 8192
    buffer_load_dwordx4 v3, s[8:11], s31 offen lds
down_kernel_sk_10:
    s_add_u32 m0, s53, 0
    s_add_u32 s31, s47, 0
    buffer_load_dwordx4 v3, s[4:7], s31 offen lds
    s_add_u32 m0, s53, 1024
    s_add_u32 s31, s47, 1024
    buffer_load_dwordx4 v3, s[4:7], s31 offen lds
    s_add_u32 s44, s44, 1
    s_cmp_ge_u32 s44, 27
    s_cselect_b32 s30, 27, 0
    s_sub_u32 s44, s44, s30
    s_add_u32 s46, s46, 18432
    s_cmp_ge_u32 s46, 147456
    s_cselect_b32 s30, 147456, 0
    s_sub_u32 s46, s46, s30
    s_cmp_ge_u32 s18, 2
    s_cbranch_scc1 down_kernel_w_11
    s_waitcnt vmcnt(15)
    s_branch down_kernel_w_12
down_kernel_w_11:
    s_waitcnt vmcnt(12)
down_kernel_w_12:
    s_barrier
    s_mul_i32 s47, s44, 8192
    s_add_u32 s47, s47, s50
    s_mul_i32 s48, s44, 10240
    s_add_u32 s48, s48, s51
    s_add_u32 s52, s27, s46
    s_add_u32 s53, s25, s46
    s_add_u32 m0, s52, 0
    s_add_u32 s31, s48, 0
    buffer_load_dwordx4 v3, s[8:11], s31 offen lds
    s_add_u32 m0, s52, 4096
    s_add_u32 s31, s48, 4096
    buffer_load_dwordx4 v3, s[8:11], s31 offen lds
    s_cmp_ge_u32 s18, 2
    s_cbranch_scc1 down_kernel_sk_13
    s_add_u32 m0, s52, 8192
    s_add_u32 s31, s48, 8192
    buffer_load_dwordx4 v3, s[8:11], s31 offen lds
down_kernel_sk_13:
    s_add_u32 m0, s53, 0
    s_add_u32 s31, s47, 0
    buffer_load_dwordx4 v3, s[4:7], s31 offen lds
    s_add_u32 m0, s53, 1024
    s_add_u32 s31, s47, 1024
    buffer_load_dwordx4 v3, s[4:7], s31 offen lds
    s_add_u32 s44, s44, 1
    s_cmp_ge_u32 s44, 27
    s_cselect_b32 s30, 27, 0
    s_sub_u32 s44, s44, s30
    s_add_u32 s46, s46, 18432
    s_cmp_ge_u32 s46, 147456
    s_cselect_b32 s30, 147456, 0
    s_sub_u32 s46, s46, s30
    s_mul_i32 s47, s44, 8192
    s_add_u32 s47, s47, s50
    s_mul_i32 s48, s44, 10240
    s_add_u32 s48, s48, s51
    s_add_u32 s52, s27, s46
    s_add_u32 s53, s25, s46
    s_add_u32 m0, s52, 0
    s_add_u32 s31, s48, 0
    buffer_load_dwordx4 v3, s[8:11], s31 offen lds
    s_add_u32 m0, s52, 4096
    s_add_u32 s31, s48, 4096
    buffer_load_dwordx4 v3, s[8:11], s31 offen lds
    s_cmp_ge_u32 s18, 2
    s_cbranch_scc1 down_kernel_sk_14
    s_add_u32 m0, s52, 8192
    s_add_u32 s31, s48, 8192
    buffer_load_dwordx4 v3, s[8:11], s31 offen lds
down_kernel_sk_14:
    s_add_u32 m0, s53, 0
    s_add_u32 s31, s47, 0
    buffer_load_dwordx4 v3, s[4:7], s31 offen lds
    s_add_u32 m0, s53, 1024
    s_add_u32 s31, s47, 1024
    buffer_load_dwordx4 v3, s[4:7], s31 offen lds
    s_add_u32 s44, s44, 1
    s_cmp_ge_u32 s44, 27
    s_cselect_b32 s30, 27, 0
    s_sub_u32 s44, s44, s30
    s_add_u32 s46, s46, 18432
    s_cmp_ge_u32 s46, 147456
    s_cselect_b32 s30, 147456, 0
    s_sub_u32 s46, s46, s30
    s_cmp_ge_u32 s18, 2
    s_cbranch_scc1 down_kernel_w_15
    s_waitcnt vmcnt(20)
    s_branch down_kernel_w_16
down_kernel_w_15:
    s_waitcnt vmcnt(16)
down_kernel_w_16:
    s_barrier
    s_mul_i32 s47, s44, 8192
    s_add_u32 s47, s47, s50
    s_mul_i32 s48, s44, 10240
    s_add_u32 s48, s48, s51
    s_add_u32 s52, s27, s46
    s_add_u32 s53, s25, s46
    s_add_u32 m0, s52, 0
    s_add_u32 s31, s48, 0
    buffer_load_dwordx4 v3, s[8:11], s31 offen lds
    s_add_u32 m0, s52, 4096
    s_add_u32 s31, s48, 4096
    buffer_load_dwordx4 v3, s[8:11], s31 offen lds
    s_cmp_ge_u32 s18, 2
    s_cbranch_scc1 down_kernel_sk_17
    s_add_u32 m0, s52, 8192
    s_add_u32 s31, s48, 8192
    buffer_load_dwordx4 v3, s[8:11], s31 offen lds
down_kernel_sk_17:
    s_add_u32 m0, s53, 0
    s_add_u32 s31, s47, 0
    buffer_load_dwordx4 v3, s[4:7], s31 offen lds
    s_add_u32 m0, s53, 1024
    s_add_u32 s31, s47, 1024
    buffer_load_dwordx4 v3, s[4:7], s31 offen lds
    s_add_u32 s44, s44, 1
    s_cmp_ge_u32 s44, 27
    s_cselect_b32 s30, 27, 0
    s_sub_u32 s44, s44, s30
    s_add_u32 s46, s46, 18432
    s_cmp_ge_u32 s46, 147456
    s_cselect_b32 s30, 147456, 0
    s_sub_u32 s46, s46, s30
    s_mul_i32 s47, s44, 8192
    s_add_u32 s47, s47, s50
    s_mul_i32 s48, s44, 10240
    s_add_u32 s48, s48, s51
    s_add_u32 s52, s27, s46
    s_add_u32 s53, s25, s46
    s_add_u32 m0, s52, 0
    s_add_u32 s31, s48, 0
    buffer_load_dwordx4 v3, s[8:11], s31 offen lds
    s_add_u32 m0, s52, 4096
    s_add_u32 s31, s48, 4096
    buffer_load_dwordx4 v3, s[8:11], s31 offen lds
    s_cmp_ge_u32 s18, 2
    s_cbranch_scc1 down_kernel_sk_18
    s_add_u32 m0, s52, 8192
    s_add_u32 s31, s48, 8192
    buffer_load_dwordx4 v3, s[8:11], s31 offen lds
down_kernel_sk_18:
    s_add_u32 m0, s53, 0
    s_add_u32 s31, s47, 0
    buffer_load_dwordx4 v3, s[4:7], s31 offen lds
    s_add_u32 m0, s53, 1024
    s_add_u32 s31, s47, 1024
    buffer_load_dwordx4 v3, s[4:7], s31 offen lds
    s_add_u32 s44, s44, 1
    s_cmp_ge_u32 s44, 27
    s_cselect_b32 s30, 27, 0
    s_sub_u32 s44, s44, s30
    s_add_u32 s46, s46, 18432
    s_cmp_ge_u32 s46, 147456
    s_cselect_b32 s30, 147456, 0
    s_sub_u32 s46, s46, s30
    s_mov_b32 s49, 0
down_kernel_ll_19:
    s_cmp_ge_u32 s18, 2
    s_cbranch_scc1 down_kernel_w_20
    s_waitcnt vmcnt(25)
    s_branch down_kernel_w_21
down_kernel_w_20:
    s_waitcnt vmcnt(20)
down_kernel_w_21:
    s_barrier
    s_mul_i32 s47, s44, 8192
    s_add_u32 s47, s47, s50
    s_mul_i32 s48, s44, 10240
    s_add_u32 s48, s48, s51
    s_add_u32 s52, s27, s46
    s_add_u32 s53, s25, s46
    s_add_u32 m0, s52, 0
    s_add_u32 s31, s48, 0
    buffer_load_dwordx4 v3, s[8:11], s31 offen lds
    s_add_u32 m0, s52, 4096
    s_add_u32 s31, s48, 4096
    buffer_load_dwordx4 v3, s[8:11], s31 offen lds
    s_cmp_ge_u32 s18, 2
    s_cbranch_scc1 down_kernel_sk_22
    s_add_u32 m0, s52, 8192
    s_add_u32 s31, s48, 8192
    buffer_load_dwordx4 v3, s[8:11], s31 offen lds
down_kernel_sk_22:
    s_add_u32 m0, s53, 0
    s_add_u32 s31, s47, 0
    buffer_load_dwordx4 v3, s[4:7], s31 offen lds
    s_add_u32 m0, s53, 1024
    s_add_u32 s31, s47, 1024
    buffer_load_dwordx4 v3, s[4:7], s31 offen lds
    s_add_u32 s44, s44, 1
    s_cmp_ge_u32 s44, 27
    s_cselect_b32 s30, 27, 0
    s_sub_u32 s44, s44, s30
    s_add_u32 s46, s46, 18432
    s_cmp_ge_u32 s46, 147456
    s_cselect_b32 s30, 147456, 0
    s_sub_u32 s46, s46, s30
    s_add_u32 s49, s49, 1
    s_cmp_lt_u32 s49, 17
    s_cbranch_scc1 down_kernel_ll_19
    s_cmp_ge_u32 s18, 2
    s_cbranch_scc1 down_kernel_w_23
    s_waitcnt vmcnt(25)
    s_branch down_kernel_w_24
down_kernel_w_23:
    s_waitcnt vmcnt(20)
down_kernel_w_24:
    s_barrier
    s_cmp_ge_u32 s18, 2
    s_cbranch_scc1 down_kernel_w_25
    s_waitcnt vmcnt(20)
    s_branch down_kernel_w_26
down_kernel_w_25:
    s_waitcnt vmcnt(16)
down_kernel_w_26:
    s_barrier
    s_cmp_ge_u32 s18, 2
    s_cbranch_scc1 down_kernel_w_27
    s_waitcnt vmcnt(15)
    s_branch down_kernel_w_28
down_kernel_w_27:
    s_waitcnt vmcnt(12)
down_kernel_w_28:
    s_barrier
    s_cmp_ge_u32 s18, 2
    s_cbranch_scc1 down_kernel_w_29
    s_waitcnt vmcnt(10)
    s_branch down_kernel_w_30
down_kernel_w_29:
    s_waitcnt vmcnt(8)
down_kernel_w_30:
    s_barrier
    s_cmp_ge_u32 s18, 2
    s_cbranch_scc1 down_kernel_w_31
    s_waitcnt vmcnt(5)
    s_branch down_kernel_w_32
down_kernel_w_31:
    s_waitcnt vmcnt(4)
down_kernel_w_32:
    s_barrier
    s_cmp_ge_u32 s18, 2
    s_cbranch_scc1 down_kernel_w_33
    s_waitcnt vmcnt(0)
    s_branch down_kernel_w_34
down_kernel_w_33:
    s_waitcnt vmcnt(0)
down_kernel_w_34:
    s_barrier
    s_branch down_kernel_end
down_kernel_main_loader:
    v_and_b32 v3, 15, v2
    v_lshrrev_b32 v4, 4, v2
    v_mul_u32_u24 v7, 1024, v4
    v_lshl_add_u32 v7, v3, 4, v7
    s_mul_i32 s30, s18, 256
    v_add_u32 v7, s30, v7
    v_lshlrev_b32 v8, 4, v2
    v_add_u32 v8, 8192, v8
    v_mov_b32 v40, 0
    v_mov_b32 v41, 0
    v_mov_b32 v42, 0
    v_mov_b32 v43, 0
    v_mov_b32 v44, 0
    v_mov_b32 v45, 0
    v_mov_b32 v46, 0
    v_mov_b32 v47, 0
    v_mov_b32 v48, 0
    v_mov_b32 v49, 0
    v_mov_b32 v50, 0
    v_mov_b32 v51, 0
    v_mov_b32 v52, 0
    v_mov_b32 v53, 0
    v_mov_b32 v54, 0
    v_mov_b32 v55, 0
    v_mov_b32 v56, 0
    v_mov_b32 v57, 0
    v_mov_b32 v58, 0
    v_mov_b32 v59, 0
    v_lshrrev_b32 v60, 4, v2
    v_and_b32 v61, 15, v2
    s_mul_i32 s30, s16, 64
    s_mul_i32 s31, s18, 16
    s_add_u32 s30, s30, s31
    v_add_u32 v61, s30, v61
    s_lshr_b32 s29, s30, 6
    v_and_b32 v3, 63, v61
    v_lshlrev_b32 v3, 4, v3
    v_lshrrev_b32 v4, 1, v60
    v_lshl_add_u32 v3, v4, 10, v3
    v_and_b32 v4, 1, v60
    v_lshl_add_u32 v62, v4, 3, v3
    s_waitcnt lgkmcnt(0)
    s_mov_b32 s49, 0
    s_mov_b32 s45, 0
    s_barrier
    v_add_u32 v9, s45, v7
    v_add_u32 v10, s45, v8
    ds_read_b128 v[12:15], v9 offset:0
    ds_read_b128 v[20:23], v10 offset:0
    ds_read_b128 v[24:27], v10 offset:1024
    ds_read_b128 v[28:31], v10 offset:2048
    ds_read_b128 v[32:35], v10 offset:3072
    ds_read_b128 v[36:39], v10 offset:4096
    s_mov_b32 s12, s78
    s_mov_b32 s13, s79
    s_mov_b32 s14, 2621440
    s_mov_b32 s15, 0x00020000
    s_add_u32 s36, s82, 10485760
    s_addc_u32 s37, s83, 0
    s_mov_b32 s38, 2621440
    s_mov_b32 s39, 0x00020000
    s_add_u32 s40, s82, 20201472
    s_addc_u32 s41, s83, 0
    s_mov_b32 s42, 131072
    s_mov_b32 s43, 0x00020000
    s_mul_i32 s30, s17, 10240
    s_mul_i32 s31, s29, 81920
    s_add_u32 s30, s30, s31
    buffer_load_dwordx2 v[64:65], v62, s[36:39], s30 offen offset:0
    buffer_load_dwordx2 v[66:67], v62, s[36:39], s30 offen offset:2048
    s_add_u32 s31, s30, 4096
    buffer_load_dwordx2 v[68:69], v62, s[36:39], s31 offen
    s_add_u32 s31, s30, 6144
    buffer_load_dwordx2 v[70:71], v62, s[36:39], s31 offen
    s_add_u32 s31, s30, 8192
    buffer_load_dwordx2 v[72:73], v62, s[36:39], s31 offen
    v_lshlrev_b32 v4, 6, v61
    v_lshl_add_u32 v4, v60, 4, v4
    buffer_load_dwordx4 v[76:79], v4, s[40:43], 0 offen offset:0
down_kernel_loop:
    ds_read_b128 v[16:19], v9 offset:4096
    s_waitcnt lgkmcnt(5)
    v_mfma_f32_16x16x32_bf16 v[40:43], v[20:23], v[12:15], v[40:43]
    ds_read_b128 v[20:23], v10 offset:5120
    s_waitcnt lgkmcnt(5)
    v_mfma_f32_16x16x32_bf16 v[44:47], v[24:27], v[12:15], v[44:47]
    ds_read_b128 v[24:27], v10 offset:6144
    s_waitcnt lgkmcnt(5)
    v_mfma_f32_16x16x32_bf16 v[48:51], v[28:31], v[12:15], v[48:51]
    ds_read_b128 v[28:31], v10 offset:7168
    s_waitcnt lgkmcnt(5)
    v_mfma_f32_16x16x32_bf16 v[52:55], v[32:35], v[12:15], v[52:55]
    ds_read_b128 v[32:35], v10 offset:8192
    s_waitcnt lgkmcnt(5)
    v_mfma_f32_16x16x32_bf16 v[56:59], v[36:39], v[12:15], v[56:59]
    ds_read_b128 v[36:39], v10 offset:9216
    s_add_u32 s49, s49, 1
    s_cmp_ge_u32 s49, 27
    s_cbranch_scc1 down_kernel_tail
    s_add_u32 s45, s45, 18432
    s_cmp_ge_u32 s45, 147456
    s_cselect_b32 s30, 147456, 0
    s_sub_u32 s45, s45, s30
    s_barrier
    v_add_u32 v9, s45, v7
    v_add_u32 v10, s45, v8
    ds_read_b128 v[12:15], v9 offset:0
    s_waitcnt lgkmcnt(5)
    v_mfma_f32_16x16x32_bf16 v[40:43], v[20:23], v[16:19], v[40:43]
    ds_read_b128 v[20:23], v10 offset:0
    s_waitcnt lgkmcnt(5)
    v_mfma_f32_16x16x32_bf16 v[44:47], v[24:27], v[16:19], v[44:47]
    ds_read_b128 v[24:27], v10 offset:1024
    s_waitcnt lgkmcnt(5)
    v_mfma_f32_16x16x32_bf16 v[48:51], v[28:31], v[16:19], v[48:51]
    ds_read_b128 v[28:31], v10 offset:2048
    s_waitcnt lgkmcnt(5)
    v_mfma_f32_16x16x32_bf16 v[52:55], v[32:35], v[16:19], v[52:55]
    ds_read_b128 v[32:35], v10 offset:3072
    s_waitcnt lgkmcnt(5)
    v_mfma_f32_16x16x32_bf16 v[56:59], v[36:39], v[16:19], v[56:59]
    ds_read_b128 v[36:39], v10 offset:4096
    s_branch down_kernel_loop
down_kernel_tail:
    s_waitcnt lgkmcnt(0)
    v_mfma_f32_16x16x32_bf16 v[40:43], v[20:23], v[16:19], v[40:43]
    v_mfma_f32_16x16x32_bf16 v[44:47], v[24:27], v[16:19], v[44:47]
    v_mfma_f32_16x16x32_bf16 v[48:51], v[28:31], v[16:19], v[48:51]
    v_mfma_f32_16x16x32_bf16 v[52:55], v[32:35], v[16:19], v[52:55]
    v_mfma_f32_16x16x32_bf16 v[56:59], v[36:39], v[16:19], v[56:59]
    s_waitcnt vmcnt(0)
    v_add_f32 v76, v76, v78
    v_add_f32 v77, v77, v79
    v_mov_b32 v3, v76
    s_nop 1
    v_permlane32_swap_b32 v3, v76
    s_nop 1
    v_add_f32 v76, v76, v3
    v_mov_b32 v3, v76
    s_nop 1
    v_permlane16_swap_b32 v3, v76
    s_nop 1
    v_add_f32 v76, v76, v3
    v_mov_b32 v3, v77
    s_nop 1
    v_permlane32_swap_b32 v3, v77
    s_nop 1
    v_add_f32 v77, v77, v3
    v_mov_b32 v3, v77
    s_nop 1
    v_permlane16_swap_b32 v3, v77
    s_nop 1
    v_add_f32 v77, v77, v3
    s_mov_b32 s30, 986500301
    v_mul_f32 v80, s30, v76
    v_mul_f32 v77, s30, v77
    v_fma_f32 v77, -v80, v80, v77
    v_max_f32 v77, 0, v77
    v_add_f32 v77, 925353388, v77
    v_rsq_f32 v82, v77
    v_sub_f32 v80, 0, v80
    v_mul_u32_u24 v6, 1280, v61
    v_lshl_add_u32 v6, v60, 3, v6
    v_mul_f32 v82, 3207688728, v82
    v_lshlrev_b32 v4, 16, v64
    v_and_b32 v5, 0xffff0000, v64
    v_fma_f32 v40, v40, v82, v4
    v_fma_f32 v41, v41, v82, v5
    v_lshlrev_b32 v4, 16, v65
    v_and_b32 v5, 0xffff0000, v65
    v_fma_f32 v42, v42, v82, v4
    v_fma_f32 v43, v43, v82, v5
    v_cvt_pk_bf16_f32 v84, v40, v41
    v_cvt_pk_bf16_f32 v85, v42, v43
    buffer_store_dwordx2 v[84:85], v6, s[12:15], s28 offen offset:0
    v_lshlrev_b32 v4, 16, v66
    v_and_b32 v5, 0xffff0000, v66
    v_fma_f32 v44, v44, v82, v4
    v_fma_f32 v45, v45, v82, v5
    v_lshlrev_b32 v4, 16, v67
    v_and_b32 v5, 0xffff0000, v67
    v_fma_f32 v46, v46, v82, v4
    v_fma_f32 v47, v47, v82, v5
    v_cvt_pk_bf16_f32 v84, v44, v45
    v_cvt_pk_bf16_f32 v85, v46, v47
    buffer_store_dwordx2 v[84:85], v6, s[12:15], s28 offen offset:32
    v_lshlrev_b32 v4, 16, v68
    v_and_b32 v5, 0xffff0000, v68
    v_fma_f32 v48, v48, v82, v4
    v_fma_f32 v49, v49, v82, v5
    v_lshlrev_b32 v4, 16, v69
    v_and_b32 v5, 0xffff0000, v69
    v_fma_f32 v50, v50, v82, v4
    v_fma_f32 v51, v51, v82, v5
    v_cvt_pk_bf16_f32 v84, v48, v49
    v_cvt_pk_bf16_f32 v85, v50, v51
    buffer_store_dwordx2 v[84:85], v6, s[12:15], s28 offen offset:64
    v_lshlrev_b32 v4, 16, v70
    v_and_b32 v5, 0xffff0000, v70
    v_fma_f32 v52, v52, v82, v4
    v_fma_f32 v53, v53, v82, v5
    v_lshlrev_b32 v4, 16, v71
    v_and_b32 v5, 0xffff0000, v71
    v_fma_f32 v54, v54, v82, v4
    v_fma_f32 v55, v55, v82, v5
    v_cvt_pk_bf16_f32 v84, v52, v53
    v_cvt_pk_bf16_f32 v85, v54, v55
    buffer_store_dwordx2 v[84:85], v6, s[12:15], s28 offen offset:96
    v_lshlrev_b32 v4, 16, v72
    v_and_b32 v5, 0xffff0000, v72
    v_fma_f32 v56, v56, v82, v4
    v_fma_f32 v57, v57, v82, v5
    v_lshlrev_b32 v4, 16, v73
    v_and_b32 v5, 0xffff0000, v73
    v_fma_f32 v58, v58, v82, v4
    v_fma_f32 v59, v59, v82, v5
    v_cvt_pk_bf16_f32 v84, v56, v57
    v_cvt_pk_bf16_f32 v85, v58, v59
    buffer_store_dwordx2 v[84:85], v6, s[12:15], s28 offen offset:128
    s_branch down_kernel_end
down_kernel_end:
    s_endpgm
code_end:
.section .rodata,"a"
.p2align 6
.amdhsa_kernel qkv_kernel
  .amdhsa_next_free_vgpr 147
  .amdhsa_next_free_sgpr 102
  .amdhsa_accum_offset 148
  .amdhsa_group_segment_fixed_size 0
  .amdhsa_kernarg_size 80
  .amdhsa_user_sgpr_count 2
  .amdhsa_user_sgpr_kernarg_segment_ptr 1
  .amdhsa_system_sgpr_workgroup_id_x 1
.end_amdhsa_kernel
.p2align 6
.amdhsa_kernel attn_kernel
  .amdhsa_next_free_vgpr 124
  .amdhsa_next_free_sgpr 102
  .amdhsa_accum_offset 124
  .amdhsa_group_segment_fixed_size 0
  .amdhsa_kernarg_size 80
  .amdhsa_user_sgpr_count 2
  .amdhsa_user_sgpr_kernarg_segment_ptr 1
  .amdhsa_system_sgpr_workgroup_id_x 1
.end_amdhsa_kernel
.p2align 6
.amdhsa_kernel wo_kernel
  .amdhsa_next_free_vgpr 83
  .amdhsa_next_free_sgpr 102
  .amdhsa_accum_offset 84
  .amdhsa_group_segment_fixed_size 0
  .amdhsa_kernarg_size 80
  .amdhsa_user_sgpr_count 2
  .amdhsa_user_sgpr_kernarg_segment_ptr 1
  .amdhsa_system_sgpr_workgroup_id_x 1
.end_amdhsa_kernel
.p2align 6
.amdhsa_kernel gu_kernel
  .amdhsa_next_free_vgpr 255
  .amdhsa_next_free_sgpr 102
  .amdhsa_accum_offset 256
  .amdhsa_group_segment_fixed_size 0
  .amdhsa_kernarg_size 80
  .amdhsa_user_sgpr_count 2
  .amdhsa_user_sgpr_kernarg_segment_ptr 1
  .amdhsa_system_sgpr_workgroup_id_x 1
.end_amdhsa_kernel
.p2align 6
.amdhsa_kernel down_kernel
  .amdhsa_next_free_vgpr 86
  .amdhsa_next_free_sgpr 102
  .amdhsa_accum_offset 88
  .amdhsa_group_segment_fixed_size 0
  .amdhsa_kernarg_size 80
  .amdhsa_user_sgpr_count 2
  .amdhsa_user_sgpr_kernarg_segment_ptr 1
  .amdhsa_system_sgpr_workgroup_id_x 1
.end_amdhsa_kernel
```
